```python
import torch

def _softmax(x, axis=-1):
    return torch.softmax(x, dim=axis)
def _gelu(x):
    return torch.nn.functional.gelu(x, approximate="tanh")
def _silu(x):
    return torch.nn.functional.silu(x)
def _sigmoid(x):
    return torch.sigmoid(x)
def _layernorm(x, axis=-1, eps=1e-5):
    m = x.mean(dim=axis, keepdim=True)
    v = x.var(dim=axis, keepdim=True, unbiased=False)
    return (x - m) / torch.sqrt(v + eps)
def _scatter_add(tgt, idx, src, axis=0):
    return tgt.clone().index_add_(axis, idx, src)
def _segment_sum(src, seg, n):
    out = torch.zeros((n,) + src.shape[1:], dtype=src.dtype)
    return out.index_add_(0, seg, src)
def _pad(x, pw):
    flat = tuple(v for pair in reversed(pw) for v in pair)
    return torch.nn.functional.pad(x, flat)

kernel_name = 'sequential_preLN__sliding_block__glu_gated_geglu__prompt'

def setup_inputs():

    _w = (lambda a: (lambda t: t.to(torch.bfloat16) if t.is_floating_point() else t)(torch.as_tensor(a)))
    def _A_setup():
        B, S, D = 1, 2048, 448
        return {
            "x": _w((lambda *s: torch.randn(*s, dtype=torch.bfloat16) * 0.05)(B, S, D)),
            "wqkv": _w((lambda *s: torch.randn(*s, dtype=torch.bfloat16) * 0.05)(D, 3 * D)),
            "wo": _w((lambda *s: torch.randn(*s, dtype=torch.bfloat16) * 0.05)(D, D)),
        }
    _A_in = _A_setup()

    def _B_setup():
        B, S, Dm, Df = 1, 2048, 448, 1792
        return {
            "x": _w((lambda *s: torch.randn(*s, dtype=torch.bfloat16) * 0.05)(B, S, Dm)),
            "w_gate": _w((lambda *s: torch.randn(*s, dtype=torch.bfloat16) * 0.8)(Dm, Df) * (Dm ** -0.5)),
            "w_up": _w((lambda *s: torch.randn(*s, dtype=torch.bfloat16) * 0.8)(Dm, Df) * (Dm ** -0.5)),
            "w_down": _w((lambda *s: torch.randn(*s, dtype=torch.bfloat16) * 0.8)(Df, Dm) * (Df ** -0.5)),
        }
    _B_in = _B_setup()

    return {
        "A_x": _A_in["x"],
        "A_wqkv": _A_in["wqkv"],
        "A_wo": _A_in["wo"],
        "B_x": _B_in["x"],
        "B_w_gate": _B_in["w_gate"],
        "B_w_up": _B_in["w_up"],
        "B_w_down": _B_in["w_down"],
    }

def reference(A_x, A_wqkv, A_wo, B_x, B_w_gate, B_w_up, B_w_down):
    def _A_ref(x, wqkv, wo):
        B, S, D = x.shape
        H = 16; Dh = D // H; W = 256
        qkv = (lambda x, *d: x.permute(*d))((x @ wqkv).reshape(B, S, 3, H, Dh), 2, 0, 3, 1, 4)
        q, k, v = qkv[0], qkv[1], qkv[2]
        scores = torch.einsum("bhqd,bhkd->bhqk", q, k) * (Dh ** -0.5)
        idx = torch.arange(S)
        mask = (idx[:, None] - idx[None, :] >= 0) & (idx[:, None] - idx[None, :] < W)
        scores = torch.where(mask[None, None], scores, -1e9)
        p = _softmax(scores, axis=-1)
        o = torch.einsum("bhqk,bhkd->bhqd", p, v)
        return (lambda x, *d: x.permute(*d))(o, 0, 2, 1, 3).reshape(B, S, D) @ wo

    def _B_ref(x, w_gate, w_up, w_down):
        g = torch.einsum("bsd,df->bsf", x, w_gate)
        u = torch.einsum("bsd,df->bsf", x, w_up)
        h = _gelu(g) * u
        return torch.einsum("bsf,fd->bsd", h, w_down)

    x = A_x
    h = x + _A_ref(_layernorm(x, axis=-1), A_wqkv, A_wo)
    h2 = h + _B_ref(_layernorm(h, axis=-1), B_w_gate, B_w_up, B_w_down)
    return h2
```

```asm
; @launch grid=(256,1,1) block=(512,1,1) lds=163840
.amdgcn_target "amdgcn-amd-amdhsa--gfx950"
.text
.globl sequential_preLN__sliding_block__glu_gated_geglu__prompt_kernel
.p2align 8
.type sequential_preLN__sliding_block__glu_gated_geglu__prompt_kernel,@function
sequential_preLN__sliding_block__glu_gated_geglu__prompt_kernel:
    s_load_dwordx4 s[4:7], s[0:1], 0
    s_load_dwordx2 s[8:9], s[0:1], 16
    s_load_dwordx4 s[12:15], s[0:1], 32
    s_load_dwordx8 s[64:71], s[0:1], 48
    v_and_b32 v1, 63, v0
    v_lshrrev_b32 v2, 6, v0
    s_nop 0
    v_readfirstlane_b32 s36, v2
    s_cmp_ge_u32 s2, 256
    s_cbranch_scc1 mk_end
    s_and_b32 s57, s2, 7
    s_lshr_b32 s58, s2, 3
    s_and_b32 s59, s36, 3
    s_cmp_ge_u32 s36, 4
    s_cbranch_scc1 mk_load
    s_cmp_ge_u32 s36, 2
    s_cbranch_scc1 mk_nt
    s_cmp_eq_u32 s36, 0
    s_cselect_b32 s54, 56, 37
    s_mul_i32 s53, s2, s54
    s_lshl_b32 s53, s53, 7
    v_lshlrev_b32 v3, 7, v1
    v_mov_b32 v4, 1073741824
    v_cmp_gt_u32 vcc, s54, v1
    s_nop 1
    v_cndmask_b32 v3, v4, v3, vcc
    s_waitcnt lgkmcnt(0)
    s_cmp_eq_u32 s36, 0
    s_cselect_b32 s16, s4, s6
    s_cselect_b32 s17, s5, s7
    s_mov_b32 s18, 1835008
    s_cselect_b32 s18, s18, 1204224
    s_mov_b32 s19, 0x20000
    buffer_load_dword v2, v3, s[16:19], s53 offen
mk_nt:
    s_cmp_lg_u32 s36, 3
    s_cbranch_scc1 mk_nc
    s_getpc_b64 s[32:33]
mk_pc:
    s_sub_u32 s32, s32, mk_pc-sequential_preLN__sliding_block__glu_gated_geglu__prompt_kernel
    s_subb_u32 s33, s33, 0
    s_mul_i32 s53, s58, 13
    s_lshr_b32 s53, s53, 6
    s_mul_i32 s53, s53, 5
    s_sub_u32 s53, s58, s53
    s_lshl_b32 s53, s53, 13
    v_lshlrev_b32 v3, 7, v1
    v_add_u32 v3, s53, v3
    v_min_u32 v3, code_end-sequential_preLN__sliding_block__glu_gated_geglu__prompt_kernel, v3
    v_mov_b32 v5, s33
    v_add_co_u32 v4, vcc, s32, v3
    s_nop 1
    v_addc_co_u32 v5, vcc, 0, v5, vcc
    global_load_dword v2, v[4:5], off
mk_nc:
    s_branch mk_cons
mk_load:
    s_lshr_b32 s37, s57, 2
    s_lshl_b32 s37, s37, 3
    s_and_b32 s39, s58, 7
    s_add_u32 s37, s37, s39
    s_and_b32 s38, s57, 3
    s_lshl_b32 s38, s38, 2
    s_lshr_b32 s40, s58, 3
    s_add_u32 s38, s38, s40
    v_lshrrev_b32 v3, 3, v1
    v_and_b32 v4, 7, v1
    v_lshrrev_b32 v5, 1, v3
    s_lshl_b32 s46, s59, 5
    s_lshl_b32 s47, s37, 7
    s_add_u32 s46, s46, s47
    v_add_u32 v6, s46, v3
    v_mul_u32_u24 v6, 896, v6
    v_xor_b32 v7, v4, v5
    v_lshl_add_u32 v12, v7, 4, v6
    v_xor_b32 v7, 4, v7
    v_lshl_add_u32 v13, v7, 4, v6
    v_add_u32 v13, 6144, v13
    v_add_u32 v14, 12288, v12
    v_add_u32 v15, 12288, v13
    s_mul_i32 s41, s59, 43008
    s_mul_i32 s42, s38, 112
    s_add_u32 s41, s41, s42
    s_add_u32 s41, s41, 896
    v_and_b32 v5, 1, v5
    v_lshlrev_b32 v5, 2, v5
    v_xor_b32 v5, v4, v5
    v_mul_u32_u24 v6, 2688, v3
    v_lshl_add_u32 v6, v5, 4, v6
    v_add_u32 v6, s41, v6
    v_mov_b32 v9, 1073741824
    v_cmp_eq_u32 vcc, 7, v5
    s_nop 1
    v_cndmask_b32 v20, v6, v9, vcc
    v_add_u32 v21, 20480, v20
    s_lshl_b32 s49, s59, 12
    s_lshl_b32 s44, s59, 11
    s_add_u32 s44, s44, 16384
    s_waitcnt lgkmcnt(0)
    s_mov_b32 s16, s4
    s_mov_b32 s17, s5
    s_mov_b32 s18, 1835008
    s_mov_b32 s19, 0x20000
    s_mov_b32 s20, s6
    s_mov_b32 s21, s7
    s_mov_b32 s22, 1204224
    s_mov_b32 s23, 0x20000
    s_add_u32 m0, s49, 0
    s_movk_i32 s52, 0
    buffer_load_dwordx4 v12, s[16:19], s52 offen offset:0 lds
    buffer_load_dwordx4 v13, s[16:19], s52 offen offset:1024 lds
    buffer_load_dwordx4 v14, s[16:19], s52 offen offset:2048 lds
    buffer_load_dwordx4 v15, s[16:19], s52 offen offset:3072 lds
    s_add_u32 m0, s44, 0
    s_mov_b32 s51, 0
    buffer_load_dwordx4 v20, s[20:23], s51 offen offset:0 lds
    buffer_load_dwordx4 v21, s[20:23], s51 offen offset:1024 lds
    s_add_u32 m0, s49, 24576
    s_movk_i32 s52, 128
    buffer_load_dwordx4 v12, s[16:19], s52 offen offset:0 lds
    buffer_load_dwordx4 v13, s[16:19], s52 offen offset:1024 lds
    buffer_load_dwordx4 v14, s[16:19], s52 offen offset:2048 lds
    buffer_load_dwordx4 v15, s[16:19], s52 offen offset:3072 lds
    s_add_u32 m0, s44, 24576
    s_mov_b32 s51, 172032
    buffer_load_dwordx4 v20, s[20:23], s51 offen offset:0 lds
    buffer_load_dwordx4 v21, s[20:23], s51 offen offset:1024 lds
    s_mov_b32 s72, s70
    s_mov_b32 s73, s71
    s_mov_b32 s74, 50331648
    s_mov_b32 s75, 0x20000
    v_lshrrev_b32 v3, 2, v1
    v_mul_u32_u24 v22, 2688, v3
    v_and_b32 v4, 3, v1
    v_lshl_add_u32 v22, v4, 4, v22
    s_mul_i32 s41, s59, 43008
    s_mul_i32 s42, s38, 56
    s_add_u32 s41, s41, s42
    s_lshl_b32 s45, s59, 10
    s_waitcnt vmcnt(6)
    s_barrier
    s_add_u32 m0, s49, 49152
    s_movk_i32 s52, 256
    buffer_load_dwordx4 v12, s[16:19], s52 offen offset:0 lds
    buffer_load_dwordx4 v13, s[16:19], s52 offen offset:1024 lds
    buffer_load_dwordx4 v14, s[16:19], s52 offen offset:2048 lds
    buffer_load_dwordx4 v15, s[16:19], s52 offen offset:3072 lds
    s_add_u32 m0, s44, 49152
    s_mov_b32 s51, 344064
    buffer_load_dwordx4 v20, s[20:23], s51 offen offset:0 lds
    buffer_load_dwordx4 v21, s[20:23], s51 offen offset:1024 lds
    s_waitcnt vmcnt(6)
    s_barrier
    s_add_u32 m0, s49, 73728
    s_movk_i32 s52, 384
    buffer_load_dwordx4 v12, s[16:19], s52 offen offset:0 lds
    buffer_load_dwordx4 v13, s[16:19], s52 offen offset:1024 lds
    buffer_load_dwordx4 v14, s[16:19], s52 offen offset:2048 lds
    buffer_load_dwordx4 v15, s[16:19], s52 offen offset:3072 lds
    s_add_u32 m0, s44, 73728
    s_mov_b32 s51, 516096
    buffer_load_dwordx4 v20, s[20:23], s51 offen offset:0 lds
    buffer_load_dwordx4 v21, s[20:23], s51 offen offset:1024 lds
    s_waitcnt vmcnt(6)
    s_barrier
    s_add_u32 m0, s49, 98304
    s_movk_i32 s52, 512
    buffer_load_dwordx4 v12, s[16:19], s52 offen offset:0 lds
    buffer_load_dwordx4 v13, s[16:19], s52 offen offset:1024 lds
    buffer_load_dwordx4 v14, s[16:19], s52 offen offset:2048 lds
    buffer_load_dwordx4 v15, s[16:19], s52 offen offset:3072 lds
    s_add_u32 m0, s44, 98304
    s_mov_b32 s51, 688128
    buffer_load_dwordx4 v20, s[20:23], s51 offen offset:0 lds
    buffer_load_dwordx4 v21, s[20:23], s51 offen offset:1024 lds
    s_waitcnt vmcnt(6)
    s_barrier
    s_add_u32 m0, s49, 0
    s_movk_i32 s52, 640
    buffer_load_dwordx4 v12, s[16:19], s52 offen offset:0 lds
    buffer_load_dwordx4 v13, s[16:19], s52 offen offset:1024 lds
    buffer_load_dwordx4 v14, s[16:19], s52 offen offset:2048 lds
    buffer_load_dwordx4 v15, s[16:19], s52 offen offset:3072 lds
    s_add_u32 m0, s44, 0
    s_mov_b32 s51, 860160
    buffer_load_dwordx4 v20, s[20:23], s51 offen offset:0 lds
    buffer_load_dwordx4 v21, s[20:23], s51 offen offset:1024 lds
    s_waitcnt vmcnt(6)
    s_barrier
    s_add_u32 m0, s49, 24576
    s_movk_i32 s52, 768
    buffer_load_dwordx4 v12, s[16:19], s52 offen offset:0 lds
    buffer_load_dwordx4 v13, s[16:19], s52 offen offset:1024 lds
    buffer_load_dwordx4 v14, s[16:19], s52 offen offset:2048 lds
    buffer_load_dwordx4 v15, s[16:19], s52 offen offset:3072 lds
    s_add_u32 m0, s44, 24576
    s_mov_b32 s51, 1032192
    buffer_load_dwordx4 v20, s[20:23], s51 offen offset:0 lds
    buffer_load_dwordx4 v21, s[20:23], s51 offen offset:1024 lds
    s_waitcnt vmcnt(6)
    s_barrier
    s_mov_b32 s32, s68
    s_mov_b32 s33, s69
    s_mov_b32 s34, 256
    s_mov_b32 s35, 0x20000
    v_mov_b32 v28, 0
    v_mov_b32 v29, 1
    s_bitcmp1_b32 s59, 0
    s_cbranch_scc1 mk_lne0
    buffer_load_dword v29, v28, s[32:35], 0 offen sc1
mk_lne0:
    s_add_u32 m0, s45, 122880
    s_add_u32 s51, s41, 0
    buffer_load_dwordx4 v22, s[20:23], s51 offen lds
    s_add_u32 m0, s45, 126976
    s_add_u32 s51, s41, 172032
    buffer_load_dwordx4 v22, s[20:23], s51 offen lds
    s_add_u32 m0, s45, 131072
    s_add_u32 s51, s41, 344064
    buffer_load_dwordx4 v22, s[20:23], s51 offen lds
    s_add_u32 m0, s45, 135168
    s_add_u32 s51, s41, 516096
    buffer_load_dwordx4 v22, s[20:23], s51 offen lds
    s_add_u32 m0, s45, 139264
    s_add_u32 s51, s41, 688128
    buffer_load_dwordx4 v22, s[20:23], s51 offen lds
    s_add_u32 m0, s45, 143360
    s_add_u32 s51, s41, 860160
    buffer_load_dwordx4 v22, s[20:23], s51 offen lds
    s_add_u32 m0, s45, 147456
    s_add_u32 s51, s41, 1032192
    buffer_load_dwordx4 v22, s[20:23], s51 offen lds
    s_waitcnt vmcnt(7)
    s_barrier
    s_barrier
    v_min_u32 v3, 5, v1
    v_cmp_lt_u32 vcc, 2, v3
    s_nop 1
    v_cndmask_b32 v4, 0, 1, vcc
    v_mul_u32_u24 v5, 3, v4
    v_sub_u32 v5, v3, v5
    v_sub_u32 v5, s37, v5
    v_mov_b32 v6, s37
    v_cmp_gt_i32 vcc, 0, v5
    s_nop 1
    v_cndmask_b32 v5, v5, v6, vcc
    s_lshr_b32 s46, s38, 1
    v_lshl_add_u32 v4, v4, 3, s46
    v_lshl_add_u32 v30, v5, 4, v4
    v_lshlrev_b32 v30, 8, v30
    v_add_u32 v30, 37814272, v30
    s_mul_i32 s60, s38, 147456
    s_lshl_b32 s61, s37, 13
    s_add_u32 s60, s60, s61
    s_add_u32 s60, s60, 16777216
    v_lshlrev_b32 v8, 4, v1
    v_lshrrev_b32 v2, 5, v1
    v_lshlrev_b32 v3, 6, v2
    v_xor_b32 v6, v8, v3
    v_xor_b32 v7, 128, v6
    s_lshl_b32 s43, s59, 11
    s_mul_i32 s44, s59, 6144
    s_add_u32 s60, s60, s44
    s_add_u32 s60, s60, 2359296
    s_lshl_b32 s46, s37, 2
    s_mul_i32 s47, s59, 3
    s_add_u32 s46, s46, s47
    s_add_u32 s47, s46, 0
    s_add_u32 s48, s60, 0
    s_cmp_ge_u32 s47, 8
    s_cselect_b32 s48, s48, 1073741824
    s_add_u32 s47, s46, 1
    s_add_u32 s49, s60, 2048
    s_cmp_ge_u32 s47, 8
    s_cselect_b32 s49, s49, 1073741824
    s_add_u32 s47, s46, 2
    s_add_u32 s50, s60, 4096
    s_cmp_ge_u32 s47, 8
    s_cselect_b32 s50, s50, 1073741824
    s_and_b32 s39, s58, 3
    s_lshl_b32 s37, s57, 2
    s_add_u32 s37, s37, s39
    s_lshr_b32 s38, s58, 2
    s_lshl_b32 s42, s38, 7
    s_lshr_b32 s40, s59, 1
    s_and_b32 s41, s59, 1
    v_lshrrev_b32 v3, 3, v1
    v_and_b32 v4, 7, v1
    v_bfe_u32 v5, v1, 4, 1
    v_lshlrev_b32 v5, 2, v5
    v_xor_b32 v4, v4, v5
    v_mul_u32_u24 v16, 896, v3
    v_lshl_add_u32 v16, v4, 4, v16
    v_add_u32 v16, s42, v16
    v_add_u32 v17, 6144, v16
    s_waitcnt vmcnt(0)
    s_barrier
    v_readfirstlane_b32 s63, v29
    s_nop 0
    s_cmp_lg_u32 s63, 0
    s_cbranch_scc1 mk_lne
    s_mov_b32 s32, s68
    s_mov_b32 s33, s69
    s_mov_b32 s34, 256
    s_mov_b32 s35, 0x20000
    v_mov_b32 v24, 0
    s_mov_b32 s62, 0
mk_1:
    buffer_load_dword v25, v24, s[32:35], 0 offen sc1
    s_waitcnt vmcnt(0)
    v_readfirstlane_b32 s63, v25
    s_add_u32 s62, s62, 1
    s_cmp_lg_u32 s63, 0
    s_cbranch_scc1 mk_1d
    s_sleep 2
    s_cmp_lt_u32 s62, 131072
    s_cbranch_scc1 mk_1
mk_1d:
mk_lne:
    s_cmp_lg_u32 s59, 0
    s_cbranch_scc1 mk_2d
    s_mov_b32 s62, 0
mk_2:
    buffer_load_dword v31, v30, s[72:75], 0 offen sc1
    s_waitcnt vmcnt(0)
    v_cmp_ne_u32 vcc, s63, v31
    s_add_u32 s62, s62, 1
    s_nop 3
    s_cbranch_vccz mk_2d
    s_sleep 1
    s_cmp_lt_u32 s62, 131072
    s_cbranch_scc1 mk_2
mk_2d:
    s_barrier
    s_add_u32 m0, s44, 0
    s_nop 0
    buffer_load_dwordx4 v8, s[72:75], s48 offen sc1 lds
    buffer_load_dwordx4 v8, s[72:75], s48 offen offset:1024 sc1 lds
    s_add_u32 m0, s44, 2048
    s_nop 0
    buffer_load_dwordx4 v8, s[72:75], s49 offen sc1 lds
    buffer_load_dwordx4 v8, s[72:75], s49 offen offset:1024 sc1 lds
    s_add_u32 m0, s44, 4096
    s_nop 0
    buffer_load_dwordx4 v8, s[72:75], s50 offen sc1 lds
    buffer_load_dwordx4 v8, s[72:75], s50 offen offset:1024 sc1 lds
    s_add_u32 m0, s44, 24576
    s_add_u32 s52, s48, 2359296
    buffer_load_dwordx4 v6, s[72:75], s52 offen sc1 lds
    buffer_load_dwordx4 v7, s[72:75], s52 offen offset:1024 sc1 lds
    s_add_u32 m0, s44, 26624
    s_add_u32 s52, s49, 2359296
    buffer_load_dwordx4 v6, s[72:75], s52 offen sc1 lds
    buffer_load_dwordx4 v7, s[72:75], s52 offen offset:1024 sc1 lds
    s_add_u32 m0, s44, 28672
    s_add_u32 s52, s50, 2359296
    buffer_load_dwordx4 v6, s[72:75], s52 offen sc1 lds
    buffer_load_dwordx4 v7, s[72:75], s52 offen offset:1024 sc1 lds
    s_waitcnt vmcnt(6)
    s_barrier
    s_mov_b32 s32, s8
    s_mov_b32 s33, s9
    s_mov_b32 s34, 401408
    s_mov_b32 s35, 0x20000
    s_lshl_b32 s56, s2, 2
    s_add_u32 s56, s56, s59
    s_mul_i32 s56, s56, 512
    s_add_u32 s56, s56, 0
    v_min_u32 v28, 3, v1
    v_lshlrev_b32 v28, 7, v28
    buffer_load_dword v29, v28, s[32:35], s56 offen
    s_mov_b32 s32, s12
    s_mov_b32 s33, s13
    s_mov_b32 s34, 1605632
    s_mov_b32 s35, 0x20000
    s_lshl_b32 s56, s2, 2
    s_add_u32 s56, s56, s59
    s_mul_i32 s56, s56, 1664
    s_add_u32 s56, s56, 0
    v_min_u32 v24, 12, v1
    v_lshlrev_b32 v24, 7, v24
    buffer_load_dword v25, v24, s[32:35], s56 offen
    s_mov_b32 s32, s14
    s_mov_b32 s33, s15
    s_mov_b32 s34, 1605632
    s_mov_b32 s35, 0x20000
    s_lshl_b32 s56, s2, 2
    s_add_u32 s56, s56, s59
    s_mul_i32 s56, s56, 1664
    s_add_u32 s56, s56, 0
    v_min_u32 v26, 12, v1
    v_lshlrev_b32 v26, 7, v26
    buffer_load_dword v27, v26, s[32:35], s56 offen
    s_waitcnt vmcnt(3)
    s_barrier
    s_cmp_ge_u32 s2, 224
    s_cbranch_scc1 mk_l2skip
    s_mov_b32 s20, s8
    s_mov_b32 s21, s9
    s_mov_b32 s22, 401408
    s_mov_b32 s23, 0x20000
    v_lshrrev_b32 v3, 2, v1
    v_mul_u32_u24 v3, 896, v3
    v_and_b32 v4, 3, v1
    v_lshl_add_u32 v3, v4, 4, v3
    v_add_u32 v4, 13312, v3
    s_mov_b32 s53, s40
    s_mov_b32 s54, s41
    s_mul_i32 s55, s53, 28
    s_lshl_b32 s56, s54, 4
    s_add_u32 s55, s55, s56
    s_mul_i32 s55, s55, 896
    s_lshl_b32 s45, s53, 1
    s_add_u32 s45, s45, s54
    s_lshl_b32 s45, s45, 11
    s_add_u32 m0, s45, 49152
    s_nop 0
    buffer_load_dwordx4 v16, s[20:23], s55 offen lds
    buffer_load_dwordx4 v17, s[20:23], s55 offen offset:1024 lds
    s_add_u32 s55, s55, 50176
    s_add_u32 m0, s45, 57344
    s_nop 0
    buffer_load_dwordx4 v16, s[20:23], s55 offen lds
    buffer_load_dwordx4 v17, s[20:23], s55 offen offset:1024 lds
    s_add_u32 s55, s55, 50176
    s_add_u32 m0, s45, 65536
    s_nop 0
    buffer_load_dwordx4 v16, s[20:23], s55 offen lds
    buffer_load_dwordx4 v17, s[20:23], s55 offen offset:1024 lds
    s_add_u32 s55, s55, 50176
    s_add_u32 m0, s45, 73728
    s_nop 0
    buffer_load_dwordx4 v16, s[20:23], s55 offen lds
    buffer_load_dwordx4 v17, s[20:23], s55 offen offset:1024 lds
    s_add_u32 s55, s55, 50176
    s_add_u32 m0, s45, 81920
    s_nop 0
    buffer_load_dwordx4 v16, s[20:23], s55 offen lds
    buffer_load_dwordx4 v17, s[20:23], s55 offen offset:1024 lds
    s_add_u32 s55, s55, 50176
    s_add_u32 m0, s45, 90112
    s_nop 0
    buffer_load_dwordx4 v16, s[20:23], s55 offen lds
    buffer_load_dwordx4 v17, s[20:23], s55 offen offset:1024 lds
    s_add_u32 s55, s55, 50176
    s_add_u32 m0, s45, 98304
    s_nop 0
    buffer_load_dwordx4 v16, s[20:23], s55 offen lds
    buffer_load_dwordx4 v17, s[20:23], s55 offen offset:1024 lds
    s_add_u32 s55, s55, 50176
    s_add_u32 m0, s45, 106496
    s_nop 0
    buffer_load_dwordx4 v16, s[20:23], s55 offen lds
    buffer_load_dwordx4 v17, s[20:23], s55 offen offset:1024 lds
    s_add_u32 s55, s55, 50176
    s_lshl_b32 s46, s37, 6
    s_lshl_b32 s47, s54, 5
    s_add_u32 s46, s46, s47
    s_mul_i32 s46, s46, 896
    s_lshl_b32 s47, s53, 6
    s_add_u32 s46, s46, s47
    s_add_u32 s46, s46, s42
    s_add_u32 m0, s45, 114688
    s_nop 0
    buffer_load_dwordx4 v3, s[16:19], s46 offen lds
    buffer_load_dwordx4 v4, s[16:19], s46 offen offset:1024 lds
mk_l2skip:
    s_waitcnt vmcnt(0)
    s_lshr_b32 s46, s37, 1
    s_lshl_b32 s46, s46, 12
    s_add_u32 s46, s46, 37879808
    v_min_u32 v30, 15, v1
    v_lshlrev_b32 v30, 8, v30
    v_add_u32 v30, s46, v30
    s_lshl_b32 s11, s37, 1
    s_add_u32 s11, s11, s40
    s_mul_i32 s11, s11, 32768
    s_lshl_b32 s44, s41, 11
    s_add_u32 s11, s11, s44
    s_add_u32 s11, s11, 0
    s_mov_b32 s10, s37
    s_lshr_b32 s37, s57, 1
    s_lshl_b32 s37, s37, 2
    s_and_b32 s39, s58, 3
    s_add_u32 s37, s37, s39
    s_and_b32 s38, s57, 1
    s_mul_i32 s38, s38, 7
    s_lshr_b32 s40, s58, 2
    s_add_u32 s38, s38, s40
    s_lshl_b32 s45, s38, 8
    v_lshrrev_b32 v3, 4, v1
    s_lshl_b32 s44, s41, 2
    v_or_b32 v4, s44, v3
    v_bfe_u32 v5, v1, 1, 3
    v_xor_b32 v4, v4, v5
    v_mul_u32_u24 v10, 3584, v3
    v_lshl_add_u32 v10, v4, 5, v10
    v_and_b32 v5, 1, v1
    v_lshl_add_u32 v10, v5, 4, v10
    v_add_u32 v10, s45, v10
    v_add_u32 v11, 13312, v10
    v_add_u32 v12, 26624, v10
    v_add_u32 v13, 39936, v10
    s_lshl_b32 s47, s41, 13
    s_lshl_b32 s48, s41, 14
    s_add_u32 s48, s48, 65536
    s_cmp_eq_u32 s41, 0
    s_cselect_b32 s20, s12, s14
    s_cselect_b32 s21, s13, s15
    s_mov_b32 s22, 1605632
    s_mov_b32 s23, 0x20000
    s_barrier
    s_cmp_ge_u32 s2, 224
    s_cbranch_scc1 mk_colsum
    s_barrier
    s_cmp_lt_u32 s59, 2
    s_cbranch_scc1 mk_np3
    s_add_u32 m0, s48, 0
    s_mov_b32 s53, 0
    buffer_load_dwordx4 v10, s[20:23], s53 offen offset:0 lds
    buffer_load_dwordx4 v11, s[20:23], s53 offen offset:1024 lds
    buffer_load_dwordx4 v12, s[20:23], s53 offen offset:2048 lds
    buffer_load_dwordx4 v13, s[20:23], s53 offen offset:3072 lds
    s_add_u32 m0, s48, 4096
    s_mov_b32 s53, 57344
    buffer_load_dwordx4 v10, s[20:23], s53 offen offset:0 lds
    buffer_load_dwordx4 v11, s[20:23], s53 offen offset:1024 lds
    buffer_load_dwordx4 v12, s[20:23], s53 offen offset:2048 lds
    buffer_load_dwordx4 v13, s[20:23], s53 offen offset:3072 lds
    s_add_u32 m0, s48, 8192
    s_mov_b32 s53, 114688
    buffer_load_dwordx4 v10, s[20:23], s53 offen offset:0 lds
    buffer_load_dwordx4 v11, s[20:23], s53 offen offset:1024 lds
    buffer_load_dwordx4 v12, s[20:23], s53 offen offset:2048 lds
    buffer_load_dwordx4 v13, s[20:23], s53 offen offset:3072 lds
    s_add_u32 m0, s48, 12288
    s_mov_b32 s53, 172032
    buffer_load_dwordx4 v10, s[20:23], s53 offen offset:0 lds
    buffer_load_dwordx4 v11, s[20:23], s53 offen offset:1024 lds
    buffer_load_dwordx4 v12, s[20:23], s53 offen offset:2048 lds
    buffer_load_dwordx4 v13, s[20:23], s53 offen offset:3072 lds
mk_np3:
    s_cmp_lg_u32 s59, 0
    s_cbranch_scc1 mk_3d
    s_mov_b32 s62, 0
mk_3:
    buffer_load_dword v31, v30, s[72:75], 0 offen sc1
    s_waitcnt vmcnt(0)
    v_cmp_ne_u32 vcc, s63, v31
    s_add_u32 s62, s62, 1
    s_nop 3
    s_cbranch_vccz mk_3d
    s_sleep 1
    s_cmp_lt_u32 s62, 131072
    s_cbranch_scc1 mk_3
mk_3d:
    s_barrier
    s_add_u32 m0, s43, 0
    s_nop 0
    buffer_load_dwordx4 v8, s[72:75], s11 offen sc1 lds
    buffer_load_dwordx4 v8, s[72:75], s11 offen offset:1024 sc1 lds
    s_add_u32 s11, s11, 4096
    s_add_u32 m0, s43, 8192
    s_nop 0
    buffer_load_dwordx4 v8, s[72:75], s11 offen sc1 lds
    buffer_load_dwordx4 v8, s[72:75], s11 offen offset:1024 sc1 lds
    s_add_u32 s11, s11, 4096
    s_add_u32 m0, s43, 16384
    s_nop 0
    buffer_load_dwordx4 v8, s[72:75], s11 offen sc1 lds
    buffer_load_dwordx4 v8, s[72:75], s11 offen offset:1024 sc1 lds
    s_add_u32 s11, s11, 4096
    s_add_u32 m0, s43, 24576
    s_nop 0
    buffer_load_dwordx4 v8, s[72:75], s11 offen sc1 lds
    buffer_load_dwordx4 v8, s[72:75], s11 offen offset:1024 sc1 lds
    s_add_u32 s11, s11, 4096
    s_add_u32 m0, s43, 32768
    s_nop 0
    buffer_load_dwordx4 v8, s[72:75], s11 offen sc1 lds
    buffer_load_dwordx4 v8, s[72:75], s11 offen offset:1024 sc1 lds
    s_add_u32 s11, s11, 4096
    s_add_u32 m0, s43, 40960
    s_nop 0
    buffer_load_dwordx4 v8, s[72:75], s11 offen sc1 lds
    buffer_load_dwordx4 v8, s[72:75], s11 offen offset:1024 sc1 lds
    s_add_u32 s11, s11, 4096
    s_waitcnt vmcnt(8)
    s_barrier
    s_add_u32 m0, s43, 49152
    s_nop 0
    buffer_load_dwordx4 v8, s[72:75], s11 offen sc1 lds
    buffer_load_dwordx4 v8, s[72:75], s11 offen offset:1024 sc1 lds
    s_add_u32 s11, s11, 4096
    s_add_u32 m0, s43, 57344
    s_nop 0
    buffer_load_dwordx4 v8, s[72:75], s11 offen sc1 lds
    buffer_load_dwordx4 v8, s[72:75], s11 offen offset:1024 sc1 lds
    s_add_u32 s11, s11, 4096
    s_waitcnt vmcnt(8)
    s_barrier
    s_waitcnt vmcnt(4)
    s_barrier
    s_waitcnt vmcnt(0)
    s_barrier
    s_cmp_ge_u32 s59, 2
    s_cbranch_scc1 mk_hold
    s_lshl_b32 s50, s37, 1
    s_add_u32 s50, s50, s59
    s_mul_i32 s50, s50, 57344
    s_add_u32 s50, s50, 2097152
    s_lshl_b32 s46, s37, 12
    s_add_u32 s46, s46, 37945344
    v_min_u32 v30, 13, v1
    v_lshlrev_b32 v30, 8, v30
    v_add_u32 v30, s46, v30
    s_barrier
    s_cmp_lg_u32 s59, 0
    s_cbranch_scc1 mk_4d
    s_mov_b32 s62, 0
mk_4:
    buffer_load_dword v31, v30, s[72:75], 0 offen sc1
    s_waitcnt vmcnt(0)
    v_cmp_ne_u32 vcc, s63, v31
    s_add_u32 s62, s62, 1
    s_nop 3
    s_cbranch_vccz mk_4d
    s_sleep 1
    s_cmp_lt_u32 s62, 131072
    s_cbranch_scc1 mk_4
mk_4d:
    s_waitcnt vmcnt(0)
    s_barrier
    s_add_u32 m0, s47, 0
    s_add_u32 s52, s50, 0
    buffer_load_dwordx4 v8, s[72:75], s52 offen offset:0 sc1 lds
    buffer_load_dwordx4 v8, s[72:75], s52 offen offset:1024 sc1 lds
    buffer_load_dwordx4 v8, s[72:75], s52 offen offset:2048 sc1 lds
    buffer_load_dwordx4 v8, s[72:75], s52 offen offset:3072 sc1 lds
    s_add_u32 m0, s47, 4096
    s_add_u32 s52, s50, 28672
    buffer_load_dwordx4 v8, s[72:75], s52 offen offset:0 sc1 lds
    buffer_load_dwordx4 v8, s[72:75], s52 offen offset:1024 sc1 lds
    buffer_load_dwordx4 v8, s[72:75], s52 offen offset:2048 sc1 lds
    buffer_load_dwordx4 v8, s[72:75], s52 offen offset:3072 sc1 lds
    s_add_u32 m0, s47, 16384
    s_add_u32 s52, s50, 4096
    buffer_load_dwordx4 v8, s[72:75], s52 offen offset:0 sc1 lds
    buffer_load_dwordx4 v8, s[72:75], s52 offen offset:1024 sc1 lds
    buffer_load_dwordx4 v8, s[72:75], s52 offen offset:2048 sc1 lds
    buffer_load_dwordx4 v8, s[72:75], s52 offen offset:3072 sc1 lds
    s_add_u32 m0, s47, 20480
    s_add_u32 s52, s50, 32768
    buffer_load_dwordx4 v8, s[72:75], s52 offen offset:0 sc1 lds
    buffer_load_dwordx4 v8, s[72:75], s52 offen offset:1024 sc1 lds
    buffer_load_dwordx4 v8, s[72:75], s52 offen offset:2048 sc1 lds
    buffer_load_dwordx4 v8, s[72:75], s52 offen offset:3072 sc1 lds
    s_waitcnt vmcnt(8)
    s_barrier
    s_add_u32 m0, s47, 32768
    s_add_u32 s52, s50, 8192
    buffer_load_dwordx4 v8, s[72:75], s52 offen offset:0 sc1 lds
    buffer_load_dwordx4 v8, s[72:75], s52 offen offset:1024 sc1 lds
    buffer_load_dwordx4 v8, s[72:75], s52 offen offset:2048 sc1 lds
    buffer_load_dwordx4 v8, s[72:75], s52 offen offset:3072 sc1 lds
    s_add_u32 m0, s47, 36864
    s_add_u32 s52, s50, 36864
    buffer_load_dwordx4 v8, s[72:75], s52 offen offset:0 sc1 lds
    buffer_load_dwordx4 v8, s[72:75], s52 offen offset:1024 sc1 lds
    buffer_load_dwordx4 v8, s[72:75], s52 offen offset:2048 sc1 lds
    buffer_load_dwordx4 v8, s[72:75], s52 offen offset:3072 sc1 lds
    s_lshl_b32 s54, s37, 10
    s_mul_i32 s55, s59, 16384
    s_add_u32 s54, s54, s55
    s_add_u32 s54, s54, 12582912
    s_lshl_b32 s56, s59, 10
    s_add_u32 m0, s56, 49152
    s_add_u32 s55, s54, 0
    buffer_load_dwordx4 v8, s[72:75], s55 offen sc1 lds
    s_add_u32 m0, s56, 51200
    s_add_u32 s55, s54, 32768
    buffer_load_dwordx4 v8, s[72:75], s55 offen sc1 lds
    s_add_u32 m0, s56, 53248
    s_add_u32 s55, s54, 65536
    buffer_load_dwordx4 v8, s[72:75], s55 offen sc1 lds
    s_add_u32 m0, s56, 55296
    s_add_u32 s55, s54, 98304
    buffer_load_dwordx4 v8, s[72:75], s55 offen sc1 lds
    s_add_u32 m0, s56, 57344
    s_add_u32 s55, s54, 131072
    buffer_load_dwordx4 v8, s[72:75], s55 offen sc1 lds
    s_add_u32 m0, s56, 59392
    s_add_u32 s55, s54, 163840
    buffer_load_dwordx4 v8, s[72:75], s55 offen sc1 lds
    s_add_u32 m0, s56, 61440
    s_add_u32 s55, s54, 196608
    buffer_load_dwordx4 v8, s[72:75], s55 offen sc1 lds
    s_waitcnt vmcnt(15)
    s_barrier
    s_add_u32 m0, s47, 0
    s_add_u32 s52, s50, 12288
    buffer_load_dwordx4 v8, s[72:75], s52 offen offset:0 sc1 lds
    buffer_load_dwordx4 v8, s[72:75], s52 offen offset:1024 sc1 lds
    buffer_load_dwordx4 v8, s[72:75], s52 offen offset:2048 sc1 lds
    buffer_load_dwordx4 v8, s[72:75], s52 offen offset:3072 sc1 lds
    s_add_u32 m0, s47, 4096
    s_add_u32 s52, s50, 40960
    buffer_load_dwordx4 v8, s[72:75], s52 offen offset:0 sc1 lds
    buffer_load_dwordx4 v8, s[72:75], s52 offen offset:1024 sc1 lds
    buffer_load_dwordx4 v8, s[72:75], s52 offen offset:2048 sc1 lds
    buffer_load_dwordx4 v8, s[72:75], s52 offen offset:3072 sc1 lds
    s_add_u32 m0, s48, 0
    s_mov_b32 s53, 688128
    buffer_load_dwordx4 v10, s[20:23], s53 offen offset:0 lds
    buffer_load_dwordx4 v11, s[20:23], s53 offen offset:1024 lds
    buffer_load_dwordx4 v12, s[20:23], s53 offen offset:2048 lds
    buffer_load_dwordx4 v13, s[20:23], s53 offen offset:3072 lds
    s_add_u32 m0, s48, 4096
    s_mov_b32 s53, 745472
    buffer_load_dwordx4 v10, s[20:23], s53 offen offset:0 lds
    buffer_load_dwordx4 v11, s[20:23], s53 offen offset:1024 lds
    buffer_load_dwordx4 v12, s[20:23], s53 offen offset:2048 lds
    buffer_load_dwordx4 v13, s[20:23], s53 offen offset:3072 lds
    s_add_u32 m0, s48, 8192
    s_mov_b32 s53, 802816
    buffer_load_dwordx4 v10, s[20:23], s53 offen offset:0 lds
    buffer_load_dwordx4 v11, s[20:23], s53 offen offset:1024 lds
    buffer_load_dwordx4 v12, s[20:23], s53 offen offset:2048 lds
    buffer_load_dwordx4 v13, s[20:23], s53 offen offset:3072 lds
    s_add_u32 m0, s48, 12288
    s_mov_b32 s53, 860160
    buffer_load_dwordx4 v10, s[20:23], s53 offen offset:0 lds
    buffer_load_dwordx4 v11, s[20:23], s53 offen offset:1024 lds
    buffer_load_dwordx4 v12, s[20:23], s53 offen offset:2048 lds
    buffer_load_dwordx4 v13, s[20:23], s53 offen offset:3072 lds
    s_waitcnt vmcnt(31)
    s_barrier
    s_add_u32 m0, s47, 16384
    s_add_u32 s52, s50, 16384
    buffer_load_dwordx4 v8, s[72:75], s52 offen offset:0 sc1 lds
    buffer_load_dwordx4 v8, s[72:75], s52 offen offset:1024 sc1 lds
    buffer_load_dwordx4 v8, s[72:75], s52 offen offset:2048 sc1 lds
    buffer_load_dwordx4 v8, s[72:75], s52 offen offset:3072 sc1 lds
    s_add_u32 m0, s47, 20480
    s_add_u32 s52, s50, 45056
    buffer_load_dwordx4 v8, s[72:75], s52 offen offset:0 sc1 lds
    buffer_load_dwordx4 v8, s[72:75], s52 offen offset:1024 sc1 lds
    buffer_load_dwordx4 v8, s[72:75], s52 offen offset:2048 sc1 lds
    buffer_load_dwordx4 v8, s[72:75], s52 offen offset:3072 sc1 lds
    s_add_u32 m0, s48, 32768
    s_mov_b32 s53, 917504
    buffer_load_dwordx4 v10, s[20:23], s53 offen offset:0 lds
    buffer_load_dwordx4 v11, s[20:23], s53 offen offset:1024 lds
    buffer_load_dwordx4 v12, s[20:23], s53 offen offset:2048 lds
    buffer_load_dwordx4 v13, s[20:23], s53 offen offset:3072 lds
    s_add_u32 m0, s48, 36864
    s_mov_b32 s53, 974848
    buffer_load_dwordx4 v10, s[20:23], s53 offen offset:0 lds
    buffer_load_dwordx4 v11, s[20:23], s53 offen offset:1024 lds
    buffer_load_dwordx4 v12, s[20:23], s53 offen offset:2048 lds
    buffer_load_dwordx4 v13, s[20:23], s53 offen offset:3072 lds
    s_add_u32 m0, s48, 40960
    s_mov_b32 s53, 1032192
    buffer_load_dwordx4 v10, s[20:23], s53 offen offset:0 lds
    buffer_load_dwordx4 v11, s[20:23], s53 offen offset:1024 lds
    buffer_load_dwordx4 v12, s[20:23], s53 offen offset:2048 lds
    buffer_load_dwordx4 v13, s[20:23], s53 offen offset:3072 lds
    s_add_u32 m0, s48, 45056
    s_mov_b32 s53, 1089536
    buffer_load_dwordx4 v10, s[20:23], s53 offen offset:0 lds
    buffer_load_dwordx4 v11, s[20:23], s53 offen offset:1024 lds
    buffer_load_dwordx4 v12, s[20:23], s53 offen offset:2048 lds
    buffer_load_dwordx4 v13, s[20:23], s53 offen offset:3072 lds
    s_waitcnt vmcnt(24)
    s_barrier
    s_add_u32 m0, s47, 32768
    s_add_u32 s52, s50, 20480
    buffer_load_dwordx4 v8, s[72:75], s52 offen offset:0 sc1 lds
    buffer_load_dwordx4 v8, s[72:75], s52 offen offset:1024 sc1 lds
    buffer_load_dwordx4 v8, s[72:75], s52 offen offset:2048 sc1 lds
    buffer_load_dwordx4 v8, s[72:75], s52 offen offset:3072 sc1 lds
    s_add_u32 m0, s47, 36864
    s_add_u32 s52, s50, 49152
    buffer_load_dwordx4 v8, s[72:75], s52 offen offset:0 sc1 lds
    buffer_load_dwordx4 v8, s[72:75], s52 offen offset:1024 sc1 lds
    buffer_load_dwordx4 v8, s[72:75], s52 offen offset:2048 sc1 lds
    buffer_load_dwordx4 v8, s[72:75], s52 offen offset:3072 sc1 lds
    s_add_u32 m0, s48, 65536
    s_mov_b32 s53, 1146880
    buffer_load_dwordx4 v10, s[20:23], s53 offen offset:0 lds
    buffer_load_dwordx4 v11, s[20:23], s53 offen offset:1024 lds
    buffer_load_dwordx4 v12, s[20:23], s53 offen offset:2048 lds
    buffer_load_dwordx4 v13, s[20:23], s53 offen offset:3072 lds
    s_add_u32 m0, s48, 69632
    s_mov_b32 s53, 1204224
    buffer_load_dwordx4 v10, s[20:23], s53 offen offset:0 lds
    buffer_load_dwordx4 v11, s[20:23], s53 offen offset:1024 lds
    buffer_load_dwordx4 v12, s[20:23], s53 offen offset:2048 lds
    buffer_load_dwordx4 v13, s[20:23], s53 offen offset:3072 lds
    s_add_u32 m0, s48, 73728
    s_mov_b32 s53, 1261568
    buffer_load_dwordx4 v10, s[20:23], s53 offen offset:0 lds
    buffer_load_dwordx4 v11, s[20:23], s53 offen offset:1024 lds
    buffer_load_dwordx4 v12, s[20:23], s53 offen offset:2048 lds
    buffer_load_dwordx4 v13, s[20:23], s53 offen offset:3072 lds
    s_add_u32 m0, s48, 77824
    s_mov_b32 s53, 1318912
    buffer_load_dwordx4 v10, s[20:23], s53 offen offset:0 lds
    buffer_load_dwordx4 v11, s[20:23], s53 offen offset:1024 lds
    buffer_load_dwordx4 v12, s[20:23], s53 offen offset:2048 lds
    buffer_load_dwordx4 v13, s[20:23], s53 offen offset:3072 lds
    s_waitcnt vmcnt(24)
    s_barrier
    s_add_u32 m0, s47, 0
    s_add_u32 s52, s50, 24576
    buffer_load_dwordx4 v8, s[72:75], s52 offen offset:0 sc1 lds
    buffer_load_dwordx4 v8, s[72:75], s52 offen offset:1024 sc1 lds
    buffer_load_dwordx4 v8, s[72:75], s52 offen offset:2048 sc1 lds
    buffer_load_dwordx4 v8, s[72:75], s52 offen offset:3072 sc1 lds
    s_add_u32 m0, s47, 4096
    s_add_u32 s52, s50, 53248
    buffer_load_dwordx4 v8, s[72:75], s52 offen offset:0 sc1 lds
    buffer_load_dwordx4 v8, s[72:75], s52 offen offset:1024 sc1 lds
    buffer_load_dwordx4 v8, s[72:75], s52 offen offset:2048 sc1 lds
    buffer_load_dwordx4 v8, s[72:75], s52 offen offset:3072 sc1 lds
    s_add_u32 m0, s48, 0
    s_mov_b32 s53, 1376256
    buffer_load_dwordx4 v10, s[20:23], s53 offen offset:0 lds
    buffer_load_dwordx4 v11, s[20:23], s53 offen offset:1024 lds
    buffer_load_dwordx4 v12, s[20:23], s53 offen offset:2048 lds
    buffer_load_dwordx4 v13, s[20:23], s53 offen offset:3072 lds
    s_add_u32 m0, s48, 4096
    s_mov_b32 s53, 1433600
    buffer_load_dwordx4 v10, s[20:23], s53 offen offset:0 lds
    buffer_load_dwordx4 v11, s[20:23], s53 offen offset:1024 lds
    buffer_load_dwordx4 v12, s[20:23], s53 offen offset:2048 lds
    buffer_load_dwordx4 v13, s[20:23], s53 offen offset:3072 lds
    s_add_u32 m0, s48, 8192
    s_mov_b32 s53, 1490944
    buffer_load_dwordx4 v10, s[20:23], s53 offen offset:0 lds
    buffer_load_dwordx4 v11, s[20:23], s53 offen offset:1024 lds
    buffer_load_dwordx4 v12, s[20:23], s53 offen offset:2048 lds
    buffer_load_dwordx4 v13, s[20:23], s53 offen offset:3072 lds
    s_add_u32 m0, s48, 12288
    s_mov_b32 s53, 1548288
    buffer_load_dwordx4 v10, s[20:23], s53 offen offset:0 lds
    buffer_load_dwordx4 v11, s[20:23], s53 offen offset:1024 lds
    buffer_load_dwordx4 v12, s[20:23], s53 offen offset:2048 lds
    buffer_load_dwordx4 v13, s[20:23], s53 offen offset:3072 lds
    s_waitcnt vmcnt(24)
    s_barrier
    s_waitcnt vmcnt(0)
    s_barrier
    s_mov_b32 s20, s64
    s_mov_b32 s21, s65
    s_mov_b32 s22, 1605632
    s_mov_b32 s23, 0x20000
    s_lshr_b32 s46, s10, 1
    s_lshl_b32 s46, s46, 12
    s_add_u32 s46, s46, 38010880
    v_min_u32 v30, 13, v1
    v_lshlrev_b32 v30, 8, v30
    v_add_u32 v30, s46, v30
    s_lshl_b32 s48, s10, 1
    s_add_u32 s48, s48, s59
    s_mul_i32 s48, s48, 114688
    s_add_u32 s48, s48, 4194304
    s_mul_i32 s49, s59, 28672
    s_lshl_b32 s43, s59, 12
    v_add_u32 v18, 12288, v16
    v_add_u32 v19, 12288, v17
    s_barrier
    s_add_u32 m0, s43, 0
    s_add_u32 s53, s49, 0
    s_waitcnt vmcnt(6)
    buffer_load_dwordx4 v16, s[20:23], s53 offen offset:0 lds
    buffer_load_dwordx4 v17, s[20:23], s53 offen offset:1024 lds
    s_waitcnt vmcnt(6)
    buffer_load_dwordx4 v18, s[20:23], s53 offen offset:2048 lds
    buffer_load_dwordx4 v19, s[20:23], s53 offen offset:3072 lds
    s_add_u32 m0, s43, 8192
    s_add_u32 s53, s49, 57344
    s_waitcnt vmcnt(6)
    buffer_load_dwordx4 v16, s[20:23], s53 offen offset:0 lds
    buffer_load_dwordx4 v17, s[20:23], s53 offen offset:1024 lds
    s_waitcnt vmcnt(6)
    buffer_load_dwordx4 v18, s[20:23], s53 offen offset:2048 lds
    buffer_load_dwordx4 v19, s[20:23], s53 offen offset:3072 lds
    s_add_u32 m0, s43, 16384
    s_add_u32 s53, s49, 114688
    s_waitcnt vmcnt(6)
    buffer_load_dwordx4 v16, s[20:23], s53 offen offset:0 lds
    buffer_load_dwordx4 v17, s[20:23], s53 offen offset:1024 lds
    s_waitcnt vmcnt(6)
    buffer_load_dwordx4 v18, s[20:23], s53 offen offset:2048 lds
    buffer_load_dwordx4 v19, s[20:23], s53 offen offset:3072 lds
    s_add_u32 m0, s43, 24576
    s_add_u32 s53, s49, 172032
    s_waitcnt vmcnt(6)
    buffer_load_dwordx4 v16, s[20:23], s53 offen offset:0 lds
    buffer_load_dwordx4 v17, s[20:23], s53 offen offset:1024 lds
    s_waitcnt vmcnt(6)
    buffer_load_dwordx4 v18, s[20:23], s53 offen offset:2048 lds
    buffer_load_dwordx4 v19, s[20:23], s53 offen offset:3072 lds
    s_barrier
    s_barrier
    s_cmp_eq_u32 s59, 0
    s_cbranch_scc1 mk_w1s
    s_mov_b32 m0, 40960
    s_mov_b32 s53, 286720
    buffer_load_dwordx4 v16, s[20:23], s53 offen offset:0 lds
    buffer_load_dwordx4 v17, s[20:23], s53 offen offset:1024 lds
    buffer_load_dwordx4 v18, s[20:23], s53 offen offset:2048 lds
    buffer_load_dwordx4 v19, s[20:23], s53 offen offset:3072 lds
    s_mov_b32 m0, 45056
    s_mov_b32 s53, 315392
    buffer_load_dwordx4 v16, s[20:23], s53 offen offset:0 lds
    buffer_load_dwordx4 v17, s[20:23], s53 offen offset:1024 lds
    buffer_load_dwordx4 v18, s[20:23], s53 offen offset:2048 lds
    buffer_load_dwordx4 v19, s[20:23], s53 offen offset:3072 lds
    s_mov_b32 m0, 49152
    s_mov_b32 s53, 344064
    buffer_load_dwordx4 v16, s[20:23], s53 offen offset:0 lds
    buffer_load_dwordx4 v17, s[20:23], s53 offen offset:1024 lds
    buffer_load_dwordx4 v18, s[20:23], s53 offen offset:2048 lds
    buffer_load_dwordx4 v19, s[20:23], s53 offen offset:3072 lds
    s_mov_b32 m0, 53248
    s_mov_b32 s53, 372736
    buffer_load_dwordx4 v16, s[20:23], s53 offen offset:0 lds
    buffer_load_dwordx4 v17, s[20:23], s53 offen offset:1024 lds
    buffer_load_dwordx4 v18, s[20:23], s53 offen offset:2048 lds
    buffer_load_dwordx4 v19, s[20:23], s53 offen offset:3072 lds
    s_mov_b32 m0, 57344
    s_mov_b32 s53, 401408
    buffer_load_dwordx4 v16, s[20:23], s53 offen offset:0 lds
    buffer_load_dwordx4 v17, s[20:23], s53 offen offset:1024 lds
    buffer_load_dwordx4 v18, s[20:23], s53 offen offset:2048 lds
    buffer_load_dwordx4 v19, s[20:23], s53 offen offset:3072 lds
    s_mov_b32 m0, 61440
    s_mov_b32 s53, 430080
    buffer_load_dwordx4 v16, s[20:23], s53 offen offset:0 lds
    buffer_load_dwordx4 v17, s[20:23], s53 offen offset:1024 lds
    buffer_load_dwordx4 v18, s[20:23], s53 offen offset:2048 lds
    buffer_load_dwordx4 v19, s[20:23], s53 offen offset:3072 lds
    s_mov_b32 m0, 65536
    s_mov_b32 s53, 458752
    buffer_load_dwordx4 v16, s[20:23], s53 offen offset:0 lds
    buffer_load_dwordx4 v17, s[20:23], s53 offen offset:1024 lds
    buffer_load_dwordx4 v18, s[20:23], s53 offen offset:2048 lds
    buffer_load_dwordx4 v19, s[20:23], s53 offen offset:3072 lds
    s_mov_b32 m0, 69632
    s_mov_b32 s53, 487424
    buffer_load_dwordx4 v16, s[20:23], s53 offen offset:0 lds
    buffer_load_dwordx4 v17, s[20:23], s53 offen offset:1024 lds
    buffer_load_dwordx4 v18, s[20:23], s53 offen offset:2048 lds
    buffer_load_dwordx4 v19, s[20:23], s53 offen offset:3072 lds
mk_w1s:
    s_cmp_lg_u32 s59, 0
    s_cbranch_scc1 mk_5d
    s_mov_b32 s62, 0
mk_5:
    buffer_load_dword v31, v30, s[72:75], 0 offen sc1
    s_waitcnt vmcnt(0)
    v_cmp_ne_u32 vcc, s63, v31
    s_add_u32 s62, s62, 1
    s_nop 3
    s_cbranch_vccz mk_5d
    s_sleep 1
    s_cmp_lt_u32 s62, 131072
    s_cbranch_scc1 mk_5
mk_5d:
    s_barrier
    s_add_u32 m0, s43, 73728
    s_add_u32 s52, s48, 0
    buffer_load_dwordx4 v8, s[72:75], s52 offen offset:0 sc1 lds
    buffer_load_dwordx4 v8, s[72:75], s52 offen offset:1024 sc1 lds
    buffer_load_dwordx4 v8, s[72:75], s52 offen offset:2048 sc1 lds
    buffer_load_dwordx4 v8, s[72:75], s52 offen offset:3072 sc1 lds
    s_add_u32 m0, s43, 81920
    s_add_u32 s52, s48, 4096
    buffer_load_dwordx4 v8, s[72:75], s52 offen offset:0 sc1 lds
    buffer_load_dwordx4 v8, s[72:75], s52 offen offset:1024 sc1 lds
    buffer_load_dwordx4 v8, s[72:75], s52 offen offset:2048 sc1 lds
    buffer_load_dwordx4 v8, s[72:75], s52 offen offset:3072 sc1 lds
    s_add_u32 m0, s43, 90112
    s_add_u32 s52, s48, 8192
    buffer_load_dwordx4 v8, s[72:75], s52 offen offset:0 sc1 lds
    buffer_load_dwordx4 v8, s[72:75], s52 offen offset:1024 sc1 lds
    buffer_load_dwordx4 v8, s[72:75], s52 offen offset:2048 sc1 lds
    buffer_load_dwordx4 v8, s[72:75], s52 offen offset:3072 sc1 lds
    s_add_u32 m0, s43, 98304
    s_add_u32 s52, s48, 12288
    buffer_load_dwordx4 v8, s[72:75], s52 offen offset:0 sc1 lds
    buffer_load_dwordx4 v8, s[72:75], s52 offen offset:1024 sc1 lds
    buffer_load_dwordx4 v8, s[72:75], s52 offen offset:2048 sc1 lds
    buffer_load_dwordx4 v8, s[72:75], s52 offen offset:3072 sc1 lds
    s_add_u32 m0, s43, 106496
    s_add_u32 s52, s48, 16384
    buffer_load_dwordx4 v8, s[72:75], s52 offen offset:0 sc1 lds
    buffer_load_dwordx4 v8, s[72:75], s52 offen offset:1024 sc1 lds
    buffer_load_dwordx4 v8, s[72:75], s52 offen offset:2048 sc1 lds
    buffer_load_dwordx4 v8, s[72:75], s52 offen offset:3072 sc1 lds
    s_add_u32 m0, s43, 114688
    s_add_u32 s52, s48, 20480
    buffer_load_dwordx4 v8, s[72:75], s52 offen offset:0 sc1 lds
    buffer_load_dwordx4 v8, s[72:75], s52 offen offset:1024 sc1 lds
    buffer_load_dwordx4 v8, s[72:75], s52 offen offset:2048 sc1 lds
    buffer_load_dwordx4 v8, s[72:75], s52 offen offset:3072 sc1 lds
    s_waitcnt vmcnt(16)
    s_barrier
    s_add_u32 m0, s43, 122880
    s_add_u32 s52, s48, 24576
    buffer_load_dwordx4 v8, s[72:75], s52 offen offset:0 sc1 lds
    buffer_load_dwordx4 v8, s[72:75], s52 offen offset:1024 sc1 lds
    buffer_load_dwordx4 v8, s[72:75], s52 offen offset:2048 sc1 lds
    buffer_load_dwordx4 v8, s[72:75], s52 offen offset:3072 sc1 lds
    s_add_u32 m0, s43, 131072
    s_add_u32 s52, s48, 28672
    buffer_load_dwordx4 v8, s[72:75], s52 offen offset:0 sc1 lds
    buffer_load_dwordx4 v8, s[72:75], s52 offen offset:1024 sc1 lds
    buffer_load_dwordx4 v8, s[72:75], s52 offen offset:2048 sc1 lds
    buffer_load_dwordx4 v8, s[72:75], s52 offen offset:3072 sc1 lds
    s_add_u32 m0, s43, 139264
    s_add_u32 s52, s48, 32768
    buffer_load_dwordx4 v8, s[72:75], s52 offen offset:0 sc1 lds
    buffer_load_dwordx4 v8, s[72:75], s52 offen offset:1024 sc1 lds
    buffer_load_dwordx4 v8, s[72:75], s52 offen offset:2048 sc1 lds
    buffer_load_dwordx4 v8, s[72:75], s52 offen offset:3072 sc1 lds
    s_waitcnt vmcnt(20)
    s_barrier
    s_add_u32 m0, s43, 0
    s_add_u32 s53, s49, 516096
    buffer_load_dwordx4 v16, s[20:23], s53 offen offset:0 lds
    buffer_load_dwordx4 v17, s[20:23], s53 offen offset:1024 lds
    buffer_load_dwordx4 v18, s[20:23], s53 offen offset:2048 lds
    buffer_load_dwordx4 v19, s[20:23], s53 offen offset:3072 lds
    s_add_u32 m0, s43, 147456
    s_add_u32 s52, s48, 36864
    buffer_load_dwordx4 v8, s[72:75], s52 offen offset:0 sc1 lds
    buffer_load_dwordx4 v8, s[72:75], s52 offen offset:1024 sc1 lds
    buffer_load_dwordx4 v8, s[72:75], s52 offen offset:2048 sc1 lds
    buffer_load_dwordx4 v8, s[72:75], s52 offen offset:3072 sc1 lds
    s_add_u32 m0, s43, 73728
    s_add_u32 s52, s48, 40960
    buffer_load_dwordx4 v8, s[72:75], s52 offen offset:0 sc1 lds
    buffer_load_dwordx4 v8, s[72:75], s52 offen offset:1024 sc1 lds
    buffer_load_dwordx4 v8, s[72:75], s52 offen offset:2048 sc1 lds
    buffer_load_dwordx4 v8, s[72:75], s52 offen offset:3072 sc1 lds
    s_waitcnt vmcnt(24)
    s_barrier
    s_add_u32 m0, s43, 8192
    s_add_u32 s53, s49, 573440
    buffer_load_dwordx4 v16, s[20:23], s53 offen offset:0 lds
    buffer_load_dwordx4 v17, s[20:23], s53 offen offset:1024 lds
    buffer_load_dwordx4 v18, s[20:23], s53 offen offset:2048 lds
    buffer_load_dwordx4 v19, s[20:23], s53 offen offset:3072 lds
    s_add_u32 m0, s43, 16384
    s_add_u32 s53, s49, 630784
    buffer_load_dwordx4 v16, s[20:23], s53 offen offset:0 lds
    buffer_load_dwordx4 v17, s[20:23], s53 offen offset:1024 lds
    buffer_load_dwordx4 v18, s[20:23], s53 offen offset:2048 lds
    buffer_load_dwordx4 v19, s[20:23], s53 offen offset:3072 lds
    s_add_u32 m0, s43, 81920
    s_add_u32 s52, s48, 45056
    buffer_load_dwordx4 v8, s[72:75], s52 offen offset:0 sc1 lds
    buffer_load_dwordx4 v8, s[72:75], s52 offen offset:1024 sc1 lds
    buffer_load_dwordx4 v8, s[72:75], s52 offen offset:2048 sc1 lds
    buffer_load_dwordx4 v8, s[72:75], s52 offen offset:3072 sc1 lds
    s_add_u32 m0, s43, 90112
    s_add_u32 s52, s48, 49152
    buffer_load_dwordx4 v8, s[72:75], s52 offen offset:0 sc1 lds
    buffer_load_dwordx4 v8, s[72:75], s52 offen offset:1024 sc1 lds
    buffer_load_dwordx4 v8, s[72:75], s52 offen offset:2048 sc1 lds
    buffer_load_dwordx4 v8, s[72:75], s52 offen offset:3072 sc1 lds
    s_waitcnt vmcnt(32)
    s_barrier
    s_add_u32 m0, s43, 24576
    s_add_u32 s53, s49, 688128
    buffer_load_dwordx4 v16, s[20:23], s53 offen offset:0 lds
    buffer_load_dwordx4 v17, s[20:23], s53 offen offset:1024 lds
    buffer_load_dwordx4 v18, s[20:23], s53 offen offset:2048 lds
    buffer_load_dwordx4 v19, s[20:23], s53 offen offset:3072 lds
    s_add_u32 m0, s43, 32768
    s_add_u32 s53, s49, 745472
    buffer_load_dwordx4 v16, s[20:23], s53 offen offset:0 lds
    buffer_load_dwordx4 v17, s[20:23], s53 offen offset:1024 lds
    buffer_load_dwordx4 v18, s[20:23], s53 offen offset:2048 lds
    buffer_load_dwordx4 v19, s[20:23], s53 offen offset:3072 lds
    s_add_u32 m0, s43, 98304
    s_add_u32 s52, s48, 53248
    buffer_load_dwordx4 v8, s[72:75], s52 offen offset:0 sc1 lds
    buffer_load_dwordx4 v8, s[72:75], s52 offen offset:1024 sc1 lds
    buffer_load_dwordx4 v8, s[72:75], s52 offen offset:2048 sc1 lds
    buffer_load_dwordx4 v8, s[72:75], s52 offen offset:3072 sc1 lds
    s_add_u32 m0, s43, 106496
    s_add_u32 s52, s48, 57344
    buffer_load_dwordx4 v8, s[72:75], s52 offen offset:0 sc1 lds
    buffer_load_dwordx4 v8, s[72:75], s52 offen offset:1024 sc1 lds
    buffer_load_dwordx4 v8, s[72:75], s52 offen offset:2048 sc1 lds
    buffer_load_dwordx4 v8, s[72:75], s52 offen offset:3072 sc1 lds
    s_waitcnt vmcnt(36)
    s_barrier
    s_add_u32 m0, s43, 114688
    s_add_u32 s52, s48, 61440
    buffer_load_dwordx4 v8, s[72:75], s52 offen offset:0 sc1 lds
    buffer_load_dwordx4 v8, s[72:75], s52 offen offset:1024 sc1 lds
    buffer_load_dwordx4 v8, s[72:75], s52 offen offset:2048 sc1 lds
    buffer_load_dwordx4 v8, s[72:75], s52 offen offset:3072 sc1 lds
    s_add_u32 m0, s43, 122880
    s_add_u32 s52, s48, 65536
    buffer_load_dwordx4 v8, s[72:75], s52 offen offset:0 sc1 lds
    buffer_load_dwordx4 v8, s[72:75], s52 offen offset:1024 sc1 lds
    buffer_load_dwordx4 v8, s[72:75], s52 offen offset:2048 sc1 lds
    buffer_load_dwordx4 v8, s[72:75], s52 offen offset:3072 sc1 lds
    s_waitcnt vmcnt(28)
    s_barrier
    s_add_u32 m0, s43, 131072
    s_add_u32 s52, s48, 69632
    buffer_load_dwordx4 v8, s[72:75], s52 offen offset:0 sc1 lds
    buffer_load_dwordx4 v8, s[72:75], s52 offen offset:1024 sc1 lds
    buffer_load_dwordx4 v8, s[72:75], s52 offen offset:2048 sc1 lds
    buffer_load_dwordx4 v8, s[72:75], s52 offen offset:3072 sc1 lds
    s_add_u32 m0, s43, 139264
    s_add_u32 s52, s48, 73728
    buffer_load_dwordx4 v8, s[72:75], s52 offen offset:0 sc1 lds
    buffer_load_dwordx4 v8, s[72:75], s52 offen offset:1024 sc1 lds
    buffer_load_dwordx4 v8, s[72:75], s52 offen offset:2048 sc1 lds
    buffer_load_dwordx4 v8, s[72:75], s52 offen offset:3072 sc1 lds
    s_waitcnt vmcnt(20)
    s_barrier
    s_add_u32 m0, s43, 147456
    s_add_u32 s52, s48, 77824
    buffer_load_dwordx4 v8, s[72:75], s52 offen offset:0 sc1 lds
    buffer_load_dwordx4 v8, s[72:75], s52 offen offset:1024 sc1 lds
    buffer_load_dwordx4 v8, s[72:75], s52 offen offset:2048 sc1 lds
    buffer_load_dwordx4 v8, s[72:75], s52 offen offset:3072 sc1 lds
    s_add_u32 m0, s43, 73728
    s_add_u32 s52, s48, 81920
    buffer_load_dwordx4 v8, s[72:75], s52 offen offset:0 sc1 lds
    buffer_load_dwordx4 v8, s[72:75], s52 offen offset:1024 sc1 lds
    buffer_load_dwordx4 v8, s[72:75], s52 offen offset:2048 sc1 lds
    buffer_load_dwordx4 v8, s[72:75], s52 offen offset:3072 sc1 lds
    s_waitcnt vmcnt(20)
    s_barrier
    s_add_u32 m0, s43, 81920
    s_add_u32 s52, s48, 86016
    buffer_load_dwordx4 v8, s[72:75], s52 offen offset:0 sc1 lds
    buffer_load_dwordx4 v8, s[72:75], s52 offen offset:1024 sc1 lds
    buffer_load_dwordx4 v8, s[72:75], s52 offen offset:2048 sc1 lds
    buffer_load_dwordx4 v8, s[72:75], s52 offen offset:3072 sc1 lds
    s_add_u32 m0, s43, 90112
    s_add_u32 s52, s48, 90112
    buffer_load_dwordx4 v8, s[72:75], s52 offen offset:0 sc1 lds
    buffer_load_dwordx4 v8, s[72:75], s52 offen offset:1024 sc1 lds
    buffer_load_dwordx4 v8, s[72:75], s52 offen offset:2048 sc1 lds
    buffer_load_dwordx4 v8, s[72:75], s52 offen offset:3072 sc1 lds
    s_waitcnt vmcnt(20)
    s_barrier
    s_add_u32 m0, s43, 98304
    s_add_u32 s52, s48, 94208
    buffer_load_dwordx4 v8, s[72:75], s52 offen offset:0 sc1 lds
    buffer_load_dwordx4 v8, s[72:75], s52 offen offset:1024 sc1 lds
    buffer_load_dwordx4 v8, s[72:75], s52 offen offset:2048 sc1 lds
    buffer_load_dwordx4 v8, s[72:75], s52 offen offset:3072 sc1 lds
    s_add_u32 m0, s43, 106496
    s_add_u32 s52, s48, 98304
    buffer_load_dwordx4 v8, s[72:75], s52 offen offset:0 sc1 lds
    buffer_load_dwordx4 v8, s[72:75], s52 offen offset:1024 sc1 lds
    buffer_load_dwordx4 v8, s[72:75], s52 offen offset:2048 sc1 lds
    buffer_load_dwordx4 v8, s[72:75], s52 offen offset:3072 sc1 lds
    s_waitcnt vmcnt(20)
    s_barrier
    s_add_u32 m0, s43, 114688
    s_add_u32 s52, s48, 102400
    buffer_load_dwordx4 v8, s[72:75], s52 offen offset:0 sc1 lds
    buffer_load_dwordx4 v8, s[72:75], s52 offen offset:1024 sc1 lds
    buffer_load_dwordx4 v8, s[72:75], s52 offen offset:2048 sc1 lds
    buffer_load_dwordx4 v8, s[72:75], s52 offen offset:3072 sc1 lds
    s_add_u32 m0, s43, 122880
    s_add_u32 s52, s48, 106496
    buffer_load_dwordx4 v8, s[72:75], s52 offen offset:0 sc1 lds
    buffer_load_dwordx4 v8, s[72:75], s52 offen offset:1024 sc1 lds
    buffer_load_dwordx4 v8, s[72:75], s52 offen offset:2048 sc1 lds
    buffer_load_dwordx4 v8, s[72:75], s52 offen offset:3072 sc1 lds
    s_waitcnt vmcnt(20)
    s_barrier
    s_add_u32 m0, s43, 131072
    s_add_u32 s52, s48, 110592
    buffer_load_dwordx4 v8, s[72:75], s52 offen offset:0 sc1 lds
    buffer_load_dwordx4 v8, s[72:75], s52 offen offset:1024 sc1 lds
    buffer_load_dwordx4 v8, s[72:75], s52 offen offset:2048 sc1 lds
    buffer_load_dwordx4 v8, s[72:75], s52 offen offset:3072 sc1 lds
    s_waitcnt vmcnt(16)
    s_barrier
    s_waitcnt vmcnt(8)
    s_barrier
    s_waitcnt vmcnt(0)
    s_barrier
    s_barrier
    s_endpgm
mk_hold:
    s_barrier
    s_add_u32 m0, s48, 32768
    s_mov_b32 s53, 229376
    buffer_load_dwordx4 v10, s[20:23], s53 offen offset:0 lds
    buffer_load_dwordx4 v11, s[20:23], s53 offen offset:1024 lds
    buffer_load_dwordx4 v12, s[20:23], s53 offen offset:2048 lds
    buffer_load_dwordx4 v13, s[20:23], s53 offen offset:3072 lds
    s_add_u32 m0, s48, 36864
    s_mov_b32 s53, 286720
    buffer_load_dwordx4 v10, s[20:23], s53 offen offset:0 lds
    buffer_load_dwordx4 v11, s[20:23], s53 offen offset:1024 lds
    buffer_load_dwordx4 v12, s[20:23], s53 offen offset:2048 lds
    buffer_load_dwordx4 v13, s[20:23], s53 offen offset:3072 lds
    s_add_u32 m0, s48, 40960
    s_mov_b32 s53, 344064
    buffer_load_dwordx4 v10, s[20:23], s53 offen offset:0 lds
    buffer_load_dwordx4 v11, s[20:23], s53 offen offset:1024 lds
    buffer_load_dwordx4 v12, s[20:23], s53 offen offset:2048 lds
    buffer_load_dwordx4 v13, s[20:23], s53 offen offset:3072 lds
    s_add_u32 m0, s48, 45056
    s_mov_b32 s53, 401408
    buffer_load_dwordx4 v10, s[20:23], s53 offen offset:0 lds
    buffer_load_dwordx4 v11, s[20:23], s53 offen offset:1024 lds
    buffer_load_dwordx4 v12, s[20:23], s53 offen offset:2048 lds
    buffer_load_dwordx4 v13, s[20:23], s53 offen offset:3072 lds
    s_barrier
    s_barrier
    s_add_u32 m0, s48, 65536
    s_mov_b32 s53, 458752
    buffer_load_dwordx4 v10, s[20:23], s53 offen offset:0 lds
    buffer_load_dwordx4 v11, s[20:23], s53 offen offset:1024 lds
    buffer_load_dwordx4 v12, s[20:23], s53 offen offset:2048 lds
    buffer_load_dwordx4 v13, s[20:23], s53 offen offset:3072 lds
    s_add_u32 m0, s48, 69632
    s_mov_b32 s53, 516096
    buffer_load_dwordx4 v10, s[20:23], s53 offen offset:0 lds
    buffer_load_dwordx4 v11, s[20:23], s53 offen offset:1024 lds
    buffer_load_dwordx4 v12, s[20:23], s53 offen offset:2048 lds
    buffer_load_dwordx4 v13, s[20:23], s53 offen offset:3072 lds
    s_add_u32 m0, s48, 73728
    s_mov_b32 s53, 573440
    buffer_load_dwordx4 v10, s[20:23], s53 offen offset:0 lds
    buffer_load_dwordx4 v11, s[20:23], s53 offen offset:1024 lds
    buffer_load_dwordx4 v12, s[20:23], s53 offen offset:2048 lds
    buffer_load_dwordx4 v13, s[20:23], s53 offen offset:3072 lds
    s_add_u32 m0, s48, 77824
    s_mov_b32 s53, 630784
    buffer_load_dwordx4 v10, s[20:23], s53 offen offset:0 lds
    buffer_load_dwordx4 v11, s[20:23], s53 offen offset:1024 lds
    buffer_load_dwordx4 v12, s[20:23], s53 offen offset:2048 lds
    buffer_load_dwordx4 v13, s[20:23], s53 offen offset:3072 lds
    s_waitcnt vmcnt(16)
    s_barrier
    s_waitcnt vmcnt(0)
    s_mov_b32 s20, s64
    s_mov_b32 s21, s65
    s_mov_b32 s22, 1605632
    s_mov_b32 s23, 0x20000
    s_sub_u32 s40, s59, 2
    s_mul_i32 s49, s40, 28672
    s_lshl_b32 s43, s40, 12
    v_mov_b32 v9, v16
    v_add_u32 v10, s43, v8
    v_add_u32 v11, 0x10000, v10
    v_add_u32 v12, 0x10000, v11
    s_barrier
    s_barrier
    s_cmp_lg_u32 s59, 2
    s_cbranch_scc1 mk_6x
    s_lshl_b32 s46, s38, 1
    v_bfe_u32 v3, v1, 1, 1
    v_mul_u32_u24 v3, 28, v3
    v_and_b32 v4, 1, v1
    v_add3_u32 v3, v3, v4, s46
    v_lshlrev_b32 v3, 8, v3
    v_add_u32 v14, 38076416, v3
    s_mov_b32 s62, 0
mk_7:
    buffer_load_dword v15, v14, s[72:75], 0 offen sc1
    s_waitcnt vmcnt(0)
    v_cmp_ne_u32 vcc, s63, v15
    s_add_u32 s62, s62, 1
    s_nop 3
    s_cbranch_vccz mk_7d
    s_sleep 1
    s_cmp_lt_u32 s62, 131072
    s_cbranch_scc1 mk_7
mk_7d:
    v_lshrrev_b32 v3, 5, v1
    v_mul_u32_u24 v3, 6656, v3
    v_add_u32 v3, v8, v3
    s_mov_b32 m0, 63488
    s_lshl_b32 s61, s38, 9
    s_add_u32 s61, s61, 13631488
    buffer_load_dwordx4 v3, s[72:75], s61 offen sc1 lds
mk_6x:
    s_barrier
    s_barrier
    s_add_u32 s53, s49, 229376
    buffer_load_dwordx4 v[16:19], v9, s[20:23], s53 offen
    s_add_u32 s53, s49, 236544
    buffer_load_dwordx4 v[20:23], v9, s[20:23], s53 offen
    s_add_u32 s53, s49, 243712
    buffer_load_dwordx4 v[24:27], v9, s[20:23], s53 offen
    s_add_u32 s53, s49, 250880
    buffer_load_dwordx4 v[28:31], v9, s[20:23], s53 offen
    s_add_u32 s53, s49, 802816
    buffer_load_dwordx4 v[32:35], v9, s[20:23], s53 offen
    s_add_u32 s53, s49, 809984
    buffer_load_dwordx4 v[36:39], v9, s[20:23], s53 offen
    s_add_u32 s53, s49, 817152
    buffer_load_dwordx4 v[40:43], v9, s[20:23], s53 offen
    s_add_u32 s53, s49, 824320
    buffer_load_dwordx4 v[44:47], v9, s[20:23], s53 offen
    s_add_u32 s53, s49, 860160
    buffer_load_dwordx4 v[48:51], v9, s[20:23], s53 offen
    s_add_u32 s53, s49, 867328
    buffer_load_dwordx4 v[52:55], v9, s[20:23], s53 offen
    s_add_u32 s53, s49, 874496
    buffer_load_dwordx4 v[56:59], v9, s[20:23], s53 offen
    s_add_u32 s53, s49, 881664
    buffer_load_dwordx4 v[60:63], v9, s[20:23], s53 offen
    s_add_u32 s53, s49, 917504
    buffer_load_dwordx4 v[64:67], v9, s[20:23], s53 offen
    s_add_u32 s53, s49, 924672
    buffer_load_dwordx4 v[68:71], v9, s[20:23], s53 offen
    s_add_u32 s53, s49, 931840
    buffer_load_dwordx4 v[72:75], v9, s[20:23], s53 offen
    s_add_u32 s53, s49, 939008
    buffer_load_dwordx4 v[76:79], v9, s[20:23], s53 offen
    s_add_u32 s53, s49, 974848
    buffer_load_dwordx4 v[80:83], v9, s[20:23], s53 offen
    s_add_u32 s53, s49, 982016
    buffer_load_dwordx4 v[84:87], v9, s[20:23], s53 offen
    s_add_u32 s53, s49, 989184
    buffer_load_dwordx4 v[88:91], v9, s[20:23], s53 offen
    s_add_u32 s53, s49, 996352
    buffer_load_dwordx4 v[92:95], v9, s[20:23], s53 offen
    s_add_u32 s53, s49, 1032192
    buffer_load_dwordx4 v[96:99], v9, s[20:23], s53 offen
    s_add_u32 s53, s49, 1039360
    buffer_load_dwordx4 v[100:103], v9, s[20:23], s53 offen
    s_add_u32 s53, s49, 1046528
    buffer_load_dwordx4 v[104:107], v9, s[20:23], s53 offen
    s_add_u32 s53, s49, 1053696
    buffer_load_dwordx4 v[108:111], v9, s[20:23], s53 offen
    s_add_u32 s53, s49, 1089536
    buffer_load_dwordx4 v[112:115], v9, s[20:23], s53 offen
    s_add_u32 s53, s49, 1096704
    buffer_load_dwordx4 v[116:119], v9, s[20:23], s53 offen
    s_add_u32 s53, s49, 1103872
    buffer_load_dwordx4 v[120:123], v9, s[20:23], s53 offen
    s_add_u32 s53, s49, 1111040
    buffer_load_dwordx4 v[124:127], v9, s[20:23], s53 offen
    s_add_u32 s53, s49, 1146880
    buffer_load_dwordx4 v[128:131], v9, s[20:23], s53 offen
    s_add_u32 s53, s49, 1154048
    buffer_load_dwordx4 v[132:135], v9, s[20:23], s53 offen
    s_waitcnt vmcnt(30)
    s_barrier
    s_add_u32 s53, s49, 1161216
    buffer_load_dwordx4 v[136:139], v9, s[20:23], s53 offen
    s_add_u32 s53, s49, 1168384
    buffer_load_dwordx4 v[140:143], v9, s[20:23], s53 offen
    s_add_u32 s53, s49, 1204224
    buffer_load_dwordx4 v[144:147], v9, s[20:23], s53 offen
    s_add_u32 s53, s49, 1211392
    buffer_load_dwordx4 v[148:151], v9, s[20:23], s53 offen
    s_add_u32 s53, s49, 1218560
    buffer_load_dwordx4 v[152:155], v9, s[20:23], s53 offen
    s_add_u32 s53, s49, 1225728
    buffer_load_dwordx4 v[156:159], v9, s[20:23], s53 offen
    s_add_u32 s53, s49, 1261568
    buffer_load_dwordx4 v[160:163], v9, s[20:23], s53 offen
    s_add_u32 s53, s49, 1268736
    buffer_load_dwordx4 v[164:167], v9, s[20:23], s53 offen
    s_add_u32 s53, s49, 1275904
    buffer_load_dwordx4 v[168:171], v9, s[20:23], s53 offen
    s_add_u32 s53, s49, 1283072
    buffer_load_dwordx4 v[172:175], v9, s[20:23], s53 offen
    s_add_u32 s53, s49, 1318912
    buffer_load_dwordx4 v[176:179], v9, s[20:23], s53 offen
    s_add_u32 s53, s49, 1326080
    buffer_load_dwordx4 v[180:183], v9, s[20:23], s53 offen
    s_add_u32 s53, s49, 1333248
    buffer_load_dwordx4 v[184:187], v9, s[20:23], s53 offen
    s_add_u32 s53, s49, 1340416
    buffer_load_dwordx4 v[188:191], v9, s[20:23], s53 offen
    s_add_u32 s53, s49, 1376256
    buffer_load_dwordx4 v[192:195], v9, s[20:23], s53 offen
    s_add_u32 s53, s49, 1383424
    buffer_load_dwordx4 v[196:199], v9, s[20:23], s53 offen
    s_add_u32 s53, s49, 1390592
    buffer_load_dwordx4 v[200:203], v9, s[20:23], s53 offen
    s_add_u32 s53, s49, 1397760
    buffer_load_dwordx4 v[204:207], v9, s[20:23], s53 offen
    s_add_u32 s53, s49, 1433600
    buffer_load_dwordx4 v[208:211], v9, s[20:23], s53 offen
    s_add_u32 s53, s49, 1440768
    buffer_load_dwordx4 v[212:215], v9, s[20:23], s53 offen
    s_add_u32 s53, s49, 1447936
    buffer_load_dwordx4 v[216:219], v9, s[20:23], s53 offen
    s_add_u32 s53, s49, 1455104
    buffer_load_dwordx4 v[220:223], v9, s[20:23], s53 offen
    s_add_u32 s53, s49, 1490944
    buffer_load_dwordx4 v[224:227], v9, s[20:23], s53 offen
    s_add_u32 s53, s49, 1498112
    buffer_load_dwordx4 v[228:231], v9, s[20:23], s53 offen
    s_add_u32 s53, s49, 1505280
    buffer_load_dwordx4 v[232:235], v9, s[20:23], s53 offen
    s_add_u32 s53, s49, 1512448
    buffer_load_dwordx4 v[236:239], v9, s[20:23], s53 offen
    s_add_u32 s53, s49, 1548288
    buffer_load_dwordx4 v[240:243], v9, s[20:23], s53 offen
    s_add_u32 s53, s49, 1555456
    buffer_load_dwordx4 v[244:247], v9, s[20:23], s53 offen
    s_add_u32 s53, s49, 1562624
    buffer_load_dwordx4 v[248:251], v9, s[20:23], s53 offen
    s_add_u32 s53, s49, 1569792
    buffer_load_dwordx4 v[252:255], v9, s[20:23], s53 offen
    s_barrier
    s_waitcnt vmcnt(56)
    ds_write_b128 v10, v[16:19] offset:32768
    ds_write_b128 v10, v[20:23] offset:33792
    ds_write_b128 v10, v[24:27] offset:34816
    ds_write_b128 v10, v[28:31] offset:35840
    s_waitcnt vmcnt(52)
    ds_write_b128 v11, v[32:35] offset:8192
    ds_write_b128 v11, v[36:39] offset:9216
    ds_write_b128 v11, v[40:43] offset:10240
    ds_write_b128 v11, v[44:47] offset:11264
    s_waitcnt vmcnt(48)
    ds_write_b128 v11, v[48:51] offset:16384
    ds_write_b128 v11, v[52:55] offset:17408
    ds_write_b128 v11, v[56:59] offset:18432
    ds_write_b128 v11, v[60:63] offset:19456
    s_waitcnt vmcnt(44)
    ds_write_b128 v11, v[64:67] offset:24576
    ds_write_b128 v11, v[68:71] offset:25600
    ds_write_b128 v11, v[72:75] offset:26624
    ds_write_b128 v11, v[76:79] offset:27648
    s_waitcnt vmcnt(40)
    ds_write_b128 v11, v[80:83] offset:32768
    ds_write_b128 v11, v[84:87] offset:33792
    ds_write_b128 v11, v[88:91] offset:34816
    ds_write_b128 v11, v[92:95] offset:35840
    s_waitcnt vmcnt(36)
    ds_write_b128 v11, v[96:99] offset:40960
    ds_write_b128 v11, v[100:103] offset:41984
    ds_write_b128 v11, v[104:107] offset:43008
    ds_write_b128 v11, v[108:111] offset:44032
    s_waitcnt vmcnt(32)
    ds_write_b128 v11, v[112:115] offset:49152
    ds_write_b128 v11, v[116:119] offset:50176
    ds_write_b128 v11, v[120:123] offset:51200
    ds_write_b128 v11, v[124:127] offset:52224
    s_waitcnt vmcnt(28)
    ds_write_b128 v11, v[128:131] offset:57344
    ds_write_b128 v11, v[132:135] offset:58368
    ds_write_b128 v11, v[136:139] offset:59392
    ds_write_b128 v11, v[140:143] offset:60416
    s_waitcnt vmcnt(24)
    ds_write_b128 v12, v[144:147] offset:0
    ds_write_b128 v12, v[148:151] offset:1024
    ds_write_b128 v12, v[152:155] offset:2048
    ds_write_b128 v12, v[156:159] offset:3072
    s_waitcnt vmcnt(20)
    ds_write_b128 v12, v[160:163] offset:8192
    ds_write_b128 v12, v[164:167] offset:9216
    ds_write_b128 v12, v[168:171] offset:10240
    ds_write_b128 v12, v[172:175] offset:11264
    s_waitcnt vmcnt(16)
    ds_write_b128 v12, v[176:179] offset:16384
    ds_write_b128 v12, v[180:183] offset:17408
    ds_write_b128 v12, v[184:187] offset:18432
    ds_write_b128 v12, v[188:191] offset:19456
    s_waitcnt vmcnt(12)
    ds_write_b128 v10, v[192:195] offset:40960
    ds_write_b128 v10, v[196:199] offset:41984
    ds_write_b128 v10, v[200:203] offset:43008
    ds_write_b128 v10, v[204:207] offset:44032
    s_waitcnt vmcnt(8)
    ds_write_b128 v10, v[208:211] offset:49152
    ds_write_b128 v10, v[212:215] offset:50176
    ds_write_b128 v10, v[216:219] offset:51200
    ds_write_b128 v10, v[220:223] offset:52224
    s_waitcnt vmcnt(4)
    ds_write_b128 v10, v[224:227] offset:57344
    ds_write_b128 v10, v[228:231] offset:58368
    ds_write_b128 v10, v[232:235] offset:59392
    ds_write_b128 v10, v[236:239] offset:60416
    s_waitcnt vmcnt(0)
    ds_write_b128 v11, v[240:243] offset:0
    ds_write_b128 v11, v[244:247] offset:1024
    ds_write_b128 v11, v[248:251] offset:2048
    ds_write_b128 v11, v[252:255] offset:3072
    s_waitcnt lgkmcnt(0)
    s_barrier
    s_endpgm
mk_cons:
    s_lshr_b32 s37, s57, 2
    s_lshl_b32 s37, s37, 3
    s_and_b32 s39, s58, 7
    s_add_u32 s37, s37, s39
    s_and_b32 s38, s57, 3
    s_lshl_b32 s38, s38, 2
    s_lshr_b32 s40, s58, 3
    s_add_u32 s38, s38, s40
    s_waitcnt lgkmcnt(0)
    s_mov_b32 s72, s70
    s_mov_b32 s73, s71
    s_mov_b32 s74, 50331648
    s_mov_b32 s75, 0x20000
    s_cmp_lg_u32 s36, 2
    s_cbranch_scc1 mk_nfw
    s_cmp_ge_u32 s2, 256
    s_cbranch_scc1 mk_nfw
    v_min_u32 v3, 4, v1
    v_lshlrev_b32 v3, 16, v3
    s_lshl_b32 s53, s2, 8
    s_add_u32 s53, s53, 37814272
    buffer_load_dword v2, v3, s[72:75], s53 offen sc1
mk_nfw:
    s_lshl_b32 s53, s2, 2
    s_add_u32 s53, s53, s36
    s_cmp_lg_u32 s53, 2
    s_cbranch_scc1 mk_ne
    v_mov_b32 v3, 0
    s_mov_b32 s53, 37748736
    s_mov_b64 exec, 1
    buffer_load_dword v4, v3, s[72:75], s53 offen sc1
    s_mov_b32 s32, s68
    s_mov_b32 s33, s69
    s_mov_b32 s34, 256
    s_mov_b32 s35, 0x20000
    s_waitcnt vmcnt(0)
    v_add_u32 v4, 1, v4
    v_max_u32 v4, 1, v4
    buffer_store_dword v4, v3, s[32:35], 0 offen sc1
    buffer_store_dword v4, v3, s[72:75], s53 offen sc1
    s_mov_b64 exec, -1
mk_ne:
    v_mov_b32 v3, 163836
    v_mov_b32 v4, 0
    ds_write_b32 v3, v4
    v_and_b32 v3, 31, v1
    v_lshrrev_b32 v4, 5, v1
    s_lshl_b32 s49, s36, 12
    v_lshlrev_b32 v20, 7, v3
    v_add_u32 v20, s49, v20
    v_bfe_u32 v21, v3, 1, 3
    v_xor_b32 v21, v21, v4
    v_xor_b32 v22, 0, v21
    v_lshl_add_u32 v5, v22, 4, v20
    v_xor_b32 v22, 2, v21
    v_lshl_add_u32 v6, v22, 4, v20
    v_xor_b32 v22, 4, v21
    v_lshl_add_u32 v7, v22, 4, v20
    v_xor_b32 v22, 6, v21
    v_lshl_add_u32 v8, v22, 4, v20
    v_and_b32 v13, 15, v1
    v_lshrrev_b32 v14, 4, v1
    v_bfe_u32 v20, v1, 2, 2
    v_and_b32 v22, 3, v1
    v_lshlrev_b32 v22, 3, v22
    v_lshrrev_b32 v23, 1, v20
    v_lshl_add_u32 v16, v23, 6, v22
    v_and_b32 v23, 1, v14
    v_lshl_add_u32 v15, v23, 5, v16
    v_lshl_add_u32 v21, v4, 3, v20
    v_lshlrev_b32 v29, 6, v21
    v_lshlrev_b32 v21, 7, v21
    v_add_u32 v21, 16384, v21
    v_add_u32 v9, v21, v15
    v_add_u32 v15, 56, v15
    v_and_b32 v15, 127, v15
    v_add_u32 v10, v21, v15
    v_lshl_add_u32 v29, v23, 5, v29
    v_add_u32 v29, v29, v22
    v_add_u32 v31, 122880, v29
    v_lshl_add_u32 v21, v14, 3, v20
    v_lshlrev_b32 v21, 7, v21
    v_add_u32 v21, 16384, v21
    s_and_b32 s53, s36, 1
    s_mul_i32 s53, s53, 56
    v_add_u32 v16, s53, v16
    v_and_b32 v15, 127, v16
    v_add_u32 v11, v21, v15
    v_add_u32 v16, 32, v16
    v_and_b32 v15, 127, v16
    v_add_u32 v12, v21, v15
    v_mov_b32 v24, 1065369472
    v_mov_b32 v25, 1065369472
    v_mov_b32 v26, 1065369472
    v_mov_b32 v27, 1065369472
    v_mov_b32 v224, 0
    v_mov_b32 v225, 0
    v_mov_b32 v226, 0
    v_mov_b32 v227, 0
    v_mov_b32 v228, 0
    v_mov_b32 v229, 0
    v_mov_b32 v230, 0
    v_mov_b32 v231, 0
    v_mov_b32 v232, 0
    v_mov_b32 v233, 0
    v_mov_b32 v234, 0
    v_mov_b32 v235, 0
    v_mov_b32 v236, 0
    v_mov_b32 v237, 0
    v_mov_b32 v238, 0
    v_mov_b32 v239, 0
    v_and_b32 v20, 3, v1
    v_cmp_eq_u32 s[24:25], 1, v20
    v_cmp_eq_u32 s[26:27], 2, v20
    v_cmp_eq_u32 s[28:29], 3, v20
    v_cmp_lt_u32 s[30:31], 31, v1
    s_lshl_b32 s54, s36, 7
    s_add_u32 s54, s54, 151552
    v_lshlrev_b32 v18, 2, v13
    v_add_u32 v18, s54, v18
    v_lshlrev_b32 v19, 4, v4
    v_add_u32 v19, 151552, v19
    v_lshlrev_b32 v17, 4, v1
    s_mul_i32 s60, s38, 294912
    s_lshl_b32 s61, s37, 2
    s_add_u32 s61, s61, s36
    s_add_u32 s61, s61, 8
    s_lshl_b32 s61, s61, 11
    s_add_u32 s60, s60, s61
    s_add_u32 s60, s60, 19136512
    s_cmp_lt_u32 s38, 8
    s_cselect_b32 s43, 0, 0x3f80
    v_mov_b32 v23, s43
    s_lshl_b32 s51, s37, 4
    s_add_u32 s51, s51, s38
    s_lshl_b32 s51, s51, 8
    s_add_u32 s51, s51, 37814272
    s_barrier
    ds_read_b128 v[32:35], v5 offset:0
    ds_read_b64_tr_b16 v[144:145], v9 offset:0
    ds_read_b64_tr_b16 v[146:147], v9 offset:512
    ds_read_b64_tr_b16 v[148:149], v10 offset:0
    ds_read_b64_tr_b16 v[150:151], v10 offset:512
    ds_read_b64_tr_b16 v[160:161], v11 offset:0
    ds_read_b64_tr_b16 v[162:163], v11 offset:512
    ds_read_b128 v[36:39], v6 offset:0
    ds_read_b64_tr_b16 v[152:153], v9 offset:2048
    ds_read_b64_tr_b16 v[154:155], v9 offset:2560
    ds_read_b64_tr_b16 v[156:157], v10 offset:2048
    ds_read_b64_tr_b16 v[158:159], v10 offset:2560
    ds_read_b64_tr_b16 v[164:165], v12 offset:0
    ds_read_b64_tr_b16 v[166:167], v12 offset:512
    s_waitcnt lgkmcnt(11)
    v_mfma_f32_32x32x16_bf16 v[192:207], v[144:147], v[32:35], 0
    ds_read_b128 v[40:43], v7 offset:0
    ds_read_b64_tr_b16 v[168:169], v9 offset:4096
    ds_read_b64_tr_b16 v[170:171], v9 offset:4608
    s_waitcnt lgkmcnt(12)
    v_mfma_f32_32x32x16_bf16 v[208:223], v[148:151], v[32:35], 0
    ds_read_b64_tr_b16 v[172:173], v10 offset:4096
    ds_read_b64_tr_b16 v[174:175], v10 offset:4608
    ds_read_b64_tr_b16 v[184:185], v11 offset:4096
    s_waitcnt lgkmcnt(10)
    v_mfma_f32_32x32x16_bf16 v[192:207], v[152:155], v[36:39], v[192:207]
    ds_read_b64_tr_b16 v[186:187], v11 offset:4608
    ds_read_b128 v[44:47], v8 offset:0
    ds_read_b64_tr_b16 v[176:177], v9 offset:6144
    s_waitcnt lgkmcnt(11)
    v_mfma_f32_32x32x16_bf16 v[208:223], v[156:159], v[36:39], v[208:223]
    ds_read_b64_tr_b16 v[178:179], v9 offset:6656
    ds_read_b64_tr_b16 v[180:181], v10 offset:6144
    ds_read_b64_tr_b16 v[182:183], v10 offset:6656
    v_mfma_f32_4x4x4_16b_bf16 v[224:227], v[32:33], v[32:33], v[224:227]
    v_mfma_f32_4x4x4_16b_bf16 v[232:235], v[24:25], v[32:33], v[232:235]
    v_mfma_f32_4x4x4_16b_bf16 v[228:231], v[34:35], v[34:35], v[228:231]
    v_mfma_f32_4x4x4_16b_bf16 v[236:239], v[24:25], v[34:35], v[236:239]
    v_mfma_f32_4x4x4_16b_bf16 v[224:227], v[36:37], v[36:37], v[224:227]
    v_mfma_f32_4x4x4_16b_bf16 v[232:235], v[24:25], v[36:37], v[232:235]
    v_mfma_f32_4x4x4_16b_bf16 v[228:231], v[38:39], v[38:39], v[228:231]
    v_mfma_f32_4x4x4_16b_bf16 v[236:239], v[24:25], v[38:39], v[236:239]
    v_mfma_f32_16x16x32_bf16 v[240:243], v[24:27], v[160:163], 0
    ds_read_b64_tr_b16 v[188:189], v12 offset:4096
    s_waitcnt lgkmcnt(13)
    v_mfma_f32_16x16x32_bf16 v[244:247], v[24:27], v[164:167], 0
    ds_read_b64_tr_b16 v[190:191], v12 offset:4608
    s_barrier
    s_waitcnt lgkmcnt(11)
    v_mfma_f32_32x32x16_bf16 v[192:207], v[168:171], v[40:43], v[192:207]
    ds_read_b128 v[48:51], v5 offset:24576
    ds_read_b64_tr_b16 v[144:145], v9 offset:24576
    ds_read_b64_tr_b16 v[146:147], v9 offset:25088
    s_waitcnt lgkmcnt(12)
    v_mfma_f32_32x32x16_bf16 v[208:223], v[172:175], v[40:43], v[208:223]
    ds_read_b64_tr_b16 v[148:149], v10 offset:24576
    ds_read_b64_tr_b16 v[150:151], v10 offset:25088
    ds_read_b64_tr_b16 v[160:161], v11 offset:24576
    s_waitcnt lgkmcnt(10)
    v_mfma_f32_32x32x16_bf16 v[192:207], v[176:179], v[44:47], v[192:207]
    ds_read_b64_tr_b16 v[162:163], v11 offset:25088
    ds_read_b128 v[52:55], v6 offset:24576
    ds_read_b64_tr_b16 v[152:153], v9 offset:26624
    s_waitcnt lgkmcnt(11)
    v_mfma_f32_32x32x16_bf16 v[208:223], v[180:183], v[44:47], v[208:223]
    ds_read_b64_tr_b16 v[154:155], v9 offset:27136
    ds_read_b64_tr_b16 v[156:157], v10 offset:26624
    ds_read_b64_tr_b16 v[158:159], v10 offset:27136
    v_mfma_f32_4x4x4_16b_bf16 v[224:227], v[40:41], v[40:41], v[224:227]
    v_mfma_f32_4x4x4_16b_bf16 v[232:235], v[24:25], v[40:41], v[232:235]
    v_mfma_f32_4x4x4_16b_bf16 v[228:231], v[42:43], v[42:43], v[228:231]
    v_mfma_f32_4x4x4_16b_bf16 v[236:239], v[24:25], v[42:43], v[236:239]
    v_mfma_f32_4x4x4_16b_bf16 v[224:227], v[44:45], v[44:45], v[224:227]
    v_mfma_f32_4x4x4_16b_bf16 v[232:235], v[24:25], v[44:45], v[232:235]
    v_mfma_f32_4x4x4_16b_bf16 v[228:231], v[46:47], v[46:47], v[228:231]
    v_mfma_f32_4x4x4_16b_bf16 v[236:239], v[24:25], v[46:47], v[236:239]
    v_mfma_f32_16x16x32_bf16 v[240:243], v[24:27], v[184:187], v[240:243]
    ds_read_b64_tr_b16 v[164:165], v12 offset:24576
    s_waitcnt lgkmcnt(13)
    v_mfma_f32_16x16x32_bf16 v[244:247], v[24:27], v[188:191], v[244:247]
    ds_read_b64_tr_b16 v[166:167], v12 offset:25088
    s_waitcnt lgkmcnt(11)
    v_mfma_f32_32x32x16_bf16 v[192:207], v[144:147], v[48:51], v[192:207]
    ds_read_b128 v[56:59], v7 offset:24576
    ds_read_b64_tr_b16 v[168:169], v9 offset:28672
    ds_read_b64_tr_b16 v[170:171], v9 offset:29184
    s_waitcnt lgkmcnt(12)
    v_mfma_f32_32x32x16_bf16 v[208:223], v[148:151], v[48:51], v[208:223]
    ds_read_b64_tr_b16 v[172:173], v10 offset:28672
    ds_read_b64_tr_b16 v[174:175], v10 offset:29184
    ds_read_b64_tr_b16 v[184:185], v11 offset:28672
    s_waitcnt lgkmcnt(10)
    v_mfma_f32_32x32x16_bf16 v[192:207], v[152:155], v[52:55], v[192:207]
    ds_read_b64_tr_b16 v[186:187], v11 offset:29184
    ds_read_b128 v[60:63], v8 offset:24576
    ds_read_b64_tr_b16 v[176:177], v9 offset:30720
    s_waitcnt lgkmcnt(11)
    v_mfma_f32_32x32x16_bf16 v[208:223], v[156:159], v[52:55], v[208:223]
    ds_read_b64_tr_b16 v[178:179], v9 offset:31232
    ds_read_b64_tr_b16 v[180:181], v10 offset:30720
    ds_read_b64_tr_b16 v[182:183], v10 offset:31232
    v_mfma_f32_4x4x4_16b_bf16 v[224:227], v[48:49], v[48:49], v[224:227]
    v_mfma_f32_4x4x4_16b_bf16 v[232:235], v[24:25], v[48:49], v[232:235]
    v_mfma_f32_4x4x4_16b_bf16 v[228:231], v[50:51], v[50:51], v[228:231]
    v_mfma_f32_4x4x4_16b_bf16 v[236:239], v[24:25], v[50:51], v[236:239]
    v_mfma_f32_4x4x4_16b_bf16 v[224:227], v[52:53], v[52:53], v[224:227]
    v_mfma_f32_4x4x4_16b_bf16 v[232:235], v[24:25], v[52:53], v[232:235]
    v_mfma_f32_4x4x4_16b_bf16 v[228:231], v[54:55], v[54:55], v[228:231]
    v_mfma_f32_4x4x4_16b_bf16 v[236:239], v[24:25], v[54:55], v[236:239]
    v_mfma_f32_16x16x32_bf16 v[240:243], v[24:27], v[160:163], v[240:243]
    ds_read_b64_tr_b16 v[188:189], v12 offset:28672
    s_waitcnt lgkmcnt(13)
    v_mfma_f32_16x16x32_bf16 v[244:247], v[24:27], v[164:167], v[244:247]
    ds_read_b64_tr_b16 v[190:191], v12 offset:29184
    s_barrier
    s_waitcnt lgkmcnt(11)
    v_mfma_f32_32x32x16_bf16 v[192:207], v[168:171], v[56:59], v[192:207]
    ds_read_b128 v[64:67], v5 offset:49152
    ds_read_b64_tr_b16 v[144:145], v9 offset:49152
    ds_read_b64_tr_b16 v[146:147], v9 offset:49664
    s_waitcnt lgkmcnt(12)
    v_mfma_f32_32x32x16_bf16 v[208:223], v[172:175], v[56:59], v[208:223]
    ds_read_b64_tr_b16 v[148:149], v10 offset:49152
    ds_read_b64_tr_b16 v[150:151], v10 offset:49664
    ds_read_b64_tr_b16 v[160:161], v11 offset:49152
    s_waitcnt lgkmcnt(10)
    v_mfma_f32_32x32x16_bf16 v[192:207], v[176:179], v[60:63], v[192:207]
    ds_read_b64_tr_b16 v[162:163], v11 offset:49664
    ds_read_b128 v[68:71], v6 offset:49152
    ds_read_b64_tr_b16 v[152:153], v9 offset:51200
    s_waitcnt lgkmcnt(11)
    v_mfma_f32_32x32x16_bf16 v[208:223], v[180:183], v[60:63], v[208:223]
    ds_read_b64_tr_b16 v[154:155], v9 offset:51712
    ds_read_b64_tr_b16 v[156:157], v10 offset:51200
    ds_read_b64_tr_b16 v[158:159], v10 offset:51712
    v_mfma_f32_4x4x4_16b_bf16 v[224:227], v[56:57], v[56:57], v[224:227]
    v_mfma_f32_4x4x4_16b_bf16 v[232:235], v[24:25], v[56:57], v[232:235]
    v_mfma_f32_4x4x4_16b_bf16 v[228:231], v[58:59], v[58:59], v[228:231]
    v_mfma_f32_4x4x4_16b_bf16 v[236:239], v[24:25], v[58:59], v[236:239]
    v_mfma_f32_4x4x4_16b_bf16 v[224:227], v[60:61], v[60:61], v[224:227]
    v_mfma_f32_4x4x4_16b_bf16 v[232:235], v[24:25], v[60:61], v[232:235]
    v_mfma_f32_4x4x4_16b_bf16 v[228:231], v[62:63], v[62:63], v[228:231]
    v_mfma_f32_4x4x4_16b_bf16 v[236:239], v[24:25], v[62:63], v[236:239]
    v_mfma_f32_16x16x32_bf16 v[240:243], v[24:27], v[184:187], v[240:243]
    ds_read_b64_tr_b16 v[164:165], v12 offset:49152
    s_waitcnt lgkmcnt(13)
    v_mfma_f32_16x16x32_bf16 v[244:247], v[24:27], v[188:191], v[244:247]
    ds_read_b64_tr_b16 v[166:167], v12 offset:49664
    s_waitcnt lgkmcnt(11)
    v_mfma_f32_32x32x16_bf16 v[192:207], v[144:147], v[64:67], v[192:207]
    ds_read_b128 v[72:75], v7 offset:49152
    ds_read_b64_tr_b16 v[168:169], v9 offset:53248
    ds_read_b64_tr_b16 v[170:171], v9 offset:53760
    s_waitcnt lgkmcnt(12)
    v_mfma_f32_32x32x16_bf16 v[208:223], v[148:151], v[64:67], v[208:223]
    ds_read_b64_tr_b16 v[172:173], v10 offset:53248
    ds_read_b64_tr_b16 v[174:175], v10 offset:53760
    ds_read_b64_tr_b16 v[184:185], v11 offset:53248
    s_waitcnt lgkmcnt(10)
    v_mfma_f32_32x32x16_bf16 v[192:207], v[152:155], v[68:71], v[192:207]
    ds_read_b64_tr_b16 v[186:187], v11 offset:53760
    ds_read_b128 v[76:79], v8 offset:49152
    ds_read_b64_tr_b16 v[176:177], v9 offset:55296
    s_waitcnt lgkmcnt(11)
    v_mfma_f32_32x32x16_bf16 v[208:223], v[156:159], v[68:71], v[208:223]
    ds_read_b64_tr_b16 v[178:179], v9 offset:55808
    ds_read_b64_tr_b16 v[180:181], v10 offset:55296
    ds_read_b64_tr_b16 v[182:183], v10 offset:55808
    v_mfma_f32_4x4x4_16b_bf16 v[224:227], v[64:65], v[64:65], v[224:227]
    v_mfma_f32_4x4x4_16b_bf16 v[232:235], v[24:25], v[64:65], v[232:235]
    v_mfma_f32_4x4x4_16b_bf16 v[228:231], v[66:67], v[66:67], v[228:231]
    v_mfma_f32_4x4x4_16b_bf16 v[236:239], v[24:25], v[66:67], v[236:239]
    v_mfma_f32_4x4x4_16b_bf16 v[224:227], v[68:69], v[68:69], v[224:227]
    v_mfma_f32_4x4x4_16b_bf16 v[232:235], v[24:25], v[68:69], v[232:235]
    v_mfma_f32_4x4x4_16b_bf16 v[228:231], v[70:71], v[70:71], v[228:231]
    v_mfma_f32_4x4x4_16b_bf16 v[236:239], v[24:25], v[70:71], v[236:239]
    v_mfma_f32_16x16x32_bf16 v[240:243], v[24:27], v[160:163], v[240:243]
    ds_read_b64_tr_b16 v[188:189], v12 offset:53248
    s_waitcnt lgkmcnt(13)
    v_mfma_f32_16x16x32_bf16 v[244:247], v[24:27], v[164:167], v[244:247]
    ds_read_b64_tr_b16 v[190:191], v12 offset:53760
    s_barrier
    v_add_u32 v5, 73728, v5
    v_add_u32 v6, 73728, v6
    v_add_u32 v7, 73728, v7
    v_add_u32 v8, 73728, v8
    v_add_u32 v9, 73728, v9
    v_add_u32 v10, 73728, v10
    v_add_u32 v11, 73728, v11
    v_add_u32 v12, 73728, v12
    s_waitcnt lgkmcnt(11)
    v_mfma_f32_32x32x16_bf16 v[192:207], v[168:171], v[72:75], v[192:207]
    ds_read_b128 v[80:83], v5 offset:0
    ds_read_b64_tr_b16 v[144:145], v9 offset:0
    ds_read_b64_tr_b16 v[146:147], v9 offset:512
    s_waitcnt lgkmcnt(12)
    v_mfma_f32_32x32x16_bf16 v[208:223], v[172:175], v[72:75], v[208:223]
    ds_read_b64_tr_b16 v[148:149], v10 offset:0
    ds_read_b64_tr_b16 v[150:151], v10 offset:512
    ds_read_b64_tr_b16 v[160:161], v11 offset:0
    s_waitcnt lgkmcnt(10)
    v_mfma_f32_32x32x16_bf16 v[192:207], v[176:179], v[76:79], v[192:207]
    ds_read_b64_tr_b16 v[162:163], v11 offset:512
    ds_read_b128 v[84:87], v6 offset:0
    ds_read_b64_tr_b16 v[152:153], v9 offset:2048
    s_waitcnt lgkmcnt(11)
    v_mfma_f32_32x32x16_bf16 v[208:223], v[180:183], v[76:79], v[208:223]
    ds_read_b64_tr_b16 v[154:155], v9 offset:2560
    ds_read_b64_tr_b16 v[156:157], v10 offset:2048
    ds_read_b64_tr_b16 v[158:159], v10 offset:2560
    v_mfma_f32_4x4x4_16b_bf16 v[224:227], v[72:73], v[72:73], v[224:227]
    v_mfma_f32_4x4x4_16b_bf16 v[232:235], v[24:25], v[72:73], v[232:235]
    v_mfma_f32_4x4x4_16b_bf16 v[228:231], v[74:75], v[74:75], v[228:231]
    v_mfma_f32_4x4x4_16b_bf16 v[236:239], v[24:25], v[74:75], v[236:239]
    v_mfma_f32_4x4x4_16b_bf16 v[224:227], v[76:77], v[76:77], v[224:227]
    v_mfma_f32_4x4x4_16b_bf16 v[232:235], v[24:25], v[76:77], v[232:235]
    v_mfma_f32_4x4x4_16b_bf16 v[228:231], v[78:79], v[78:79], v[228:231]
    v_mfma_f32_4x4x4_16b_bf16 v[236:239], v[24:25], v[78:79], v[236:239]
    v_mfma_f32_16x16x32_bf16 v[240:243], v[24:27], v[184:187], v[240:243]
    ds_read_b64_tr_b16 v[164:165], v12 offset:0
    s_waitcnt lgkmcnt(13)
    v_mfma_f32_16x16x32_bf16 v[244:247], v[24:27], v[188:191], v[244:247]
    ds_read_b64_tr_b16 v[166:167], v12 offset:512
    s_waitcnt lgkmcnt(11)
    v_mfma_f32_32x32x16_bf16 v[192:207], v[144:147], v[80:83], v[192:207]
    ds_read_b128 v[88:91], v7 offset:0
    ds_read_b64_tr_b16 v[168:169], v9 offset:4096
    ds_read_b64_tr_b16 v[170:171], v9 offset:4608
    s_waitcnt lgkmcnt(12)
    v_mfma_f32_32x32x16_bf16 v[208:223], v[148:151], v[80:83], v[208:223]
    ds_read_b64_tr_b16 v[172:173], v10 offset:4096
    ds_read_b64_tr_b16 v[174:175], v10 offset:4608
    ds_read_b64_tr_b16 v[184:185], v11 offset:4096
    s_waitcnt lgkmcnt(10)
    v_mfma_f32_32x32x16_bf16 v[192:207], v[152:155], v[84:87], v[192:207]
    ds_read_b64_tr_b16 v[186:187], v11 offset:4608
    ds_read_b128 v[92:95], v8 offset:0
    ds_read_b64_tr_b16 v[176:177], v9 offset:6144
    s_waitcnt lgkmcnt(11)
    v_mfma_f32_32x32x16_bf16 v[208:223], v[156:159], v[84:87], v[208:223]
    ds_read_b64_tr_b16 v[178:179], v9 offset:6656
    ds_read_b64_tr_b16 v[180:181], v10 offset:6144
    ds_read_b64_tr_b16 v[182:183], v10 offset:6656
    v_mfma_f32_4x4x4_16b_bf16 v[224:227], v[80:81], v[80:81], v[224:227]
    v_mfma_f32_4x4x4_16b_bf16 v[232:235], v[24:25], v[80:81], v[232:235]
    v_mfma_f32_4x4x4_16b_bf16 v[228:231], v[82:83], v[82:83], v[228:231]
    v_mfma_f32_4x4x4_16b_bf16 v[236:239], v[24:25], v[82:83], v[236:239]
    v_mfma_f32_4x4x4_16b_bf16 v[224:227], v[84:85], v[84:85], v[224:227]
    v_mfma_f32_4x4x4_16b_bf16 v[232:235], v[24:25], v[84:85], v[232:235]
    v_mfma_f32_4x4x4_16b_bf16 v[228:231], v[86:87], v[86:87], v[228:231]
    v_mfma_f32_4x4x4_16b_bf16 v[236:239], v[24:25], v[86:87], v[236:239]
    v_mfma_f32_16x16x32_bf16 v[240:243], v[24:27], v[160:163], v[240:243]
    ds_read_b64_tr_b16 v[188:189], v12 offset:4096
    s_waitcnt lgkmcnt(13)
    v_mfma_f32_16x16x32_bf16 v[244:247], v[24:27], v[164:167], v[244:247]
    ds_read_b64_tr_b16 v[190:191], v12 offset:4608
    s_barrier
    s_waitcnt lgkmcnt(11)
    v_mfma_f32_32x32x16_bf16 v[192:207], v[168:171], v[88:91], v[192:207]
    ds_read_b128 v[96:99], v5 offset:24576
    ds_read_b64_tr_b16 v[144:145], v9 offset:24576
    ds_read_b64_tr_b16 v[146:147], v9 offset:25088
    s_waitcnt lgkmcnt(12)
    v_mfma_f32_32x32x16_bf16 v[208:223], v[172:175], v[88:91], v[208:223]
    ds_read_b64_tr_b16 v[148:149], v10 offset:24576
    ds_read_b64_tr_b16 v[150:151], v10 offset:25088
    ds_read_b64_tr_b16 v[160:161], v11 offset:24576
    s_waitcnt lgkmcnt(10)
    v_mfma_f32_32x32x16_bf16 v[192:207], v[176:179], v[92:95], v[192:207]
    ds_read_b64_tr_b16 v[162:163], v11 offset:25088
    ds_read_b128 v[100:103], v6 offset:24576
    ds_read_b64_tr_b16 v[152:153], v9 offset:26624
    s_waitcnt lgkmcnt(11)
    v_mfma_f32_32x32x16_bf16 v[208:223], v[180:183], v[92:95], v[208:223]
    ds_read_b64_tr_b16 v[154:155], v9 offset:27136
    ds_read_b64_tr_b16 v[156:157], v10 offset:26624
    ds_read_b64_tr_b16 v[158:159], v10 offset:27136
    v_mfma_f32_4x4x4_16b_bf16 v[224:227], v[88:89], v[88:89], v[224:227]
    v_mfma_f32_4x4x4_16b_bf16 v[232:235], v[24:25], v[88:89], v[232:235]
    v_mfma_f32_4x4x4_16b_bf16 v[228:231], v[90:91], v[90:91], v[228:231]
    v_mfma_f32_4x4x4_16b_bf16 v[236:239], v[24:25], v[90:91], v[236:239]
    v_mfma_f32_4x4x4_16b_bf16 v[224:227], v[92:93], v[92:93], v[224:227]
    v_mfma_f32_4x4x4_16b_bf16 v[232:235], v[24:25], v[92:93], v[232:235]
    v_mfma_f32_4x4x4_16b_bf16 v[228:231], v[94:95], v[94:95], v[228:231]
    v_mfma_f32_4x4x4_16b_bf16 v[236:239], v[24:25], v[94:95], v[236:239]
    v_mfma_f32_16x16x32_bf16 v[240:243], v[24:27], v[184:187], v[240:243]
    ds_read_b64_tr_b16 v[164:165], v12 offset:24576
    s_waitcnt lgkmcnt(13)
    v_mfma_f32_16x16x32_bf16 v[244:247], v[24:27], v[188:191], v[244:247]
    ds_read_b64_tr_b16 v[166:167], v12 offset:25088
    s_waitcnt lgkmcnt(11)
    v_mfma_f32_32x32x16_bf16 v[192:207], v[144:147], v[96:99], v[192:207]
    ds_read_b128 v[104:107], v7 offset:24576
    ds_read_b64_tr_b16 v[168:169], v9 offset:28672
    ds_read_b64_tr_b16 v[170:171], v9 offset:29184
    s_waitcnt lgkmcnt(12)
    v_mfma_f32_32x32x16_bf16 v[208:223], v[148:151], v[96:99], v[208:223]
    ds_read_b64_tr_b16 v[172:173], v10 offset:28672
    ds_read_b64_tr_b16 v[174:175], v10 offset:29184
    ds_read_b64_tr_b16 v[184:185], v11 offset:28672
    s_waitcnt lgkmcnt(10)
    v_mfma_f32_32x32x16_bf16 v[192:207], v[152:155], v[100:103], v[192:207]
    ds_read_b64_tr_b16 v[186:187], v11 offset:29184
    ds_read_b128 v[108:111], v8 offset:24576
    ds_read_b64_tr_b16 v[176:177], v9 offset:30720
    s_waitcnt lgkmcnt(11)
    v_mfma_f32_32x32x16_bf16 v[208:223], v[156:159], v[100:103], v[208:223]
    ds_read_b64_tr_b16 v[178:179], v9 offset:31232
    ds_read_b64_tr_b16 v[180:181], v10 offset:30720
    ds_read_b64_tr_b16 v[182:183], v10 offset:31232
    v_mfma_f32_4x4x4_16b_bf16 v[224:227], v[96:97], v[96:97], v[224:227]
    v_mfma_f32_4x4x4_16b_bf16 v[232:235], v[24:25], v[96:97], v[232:235]
    v_mfma_f32_4x4x4_16b_bf16 v[228:231], v[98:99], v[98:99], v[228:231]
    v_mfma_f32_4x4x4_16b_bf16 v[236:239], v[24:25], v[98:99], v[236:239]
    v_mfma_f32_4x4x4_16b_bf16 v[224:227], v[100:101], v[100:101], v[224:227]
    v_mfma_f32_4x4x4_16b_bf16 v[232:235], v[24:25], v[100:101], v[232:235]
    v_mfma_f32_4x4x4_16b_bf16 v[228:231], v[102:103], v[102:103], v[228:231]
    v_mfma_f32_4x4x4_16b_bf16 v[236:239], v[24:25], v[102:103], v[236:239]
    v_mfma_f32_16x16x32_bf16 v[240:243], v[24:27], v[160:163], v[240:243]
    ds_read_b64_tr_b16 v[188:189], v12 offset:28672
    s_waitcnt lgkmcnt(13)
    v_mfma_f32_16x16x32_bf16 v[244:247], v[24:27], v[164:167], v[244:247]
    ds_read_b64_tr_b16 v[190:191], v12 offset:29184
    s_barrier
    v_add_u32 v5, 4294893568, v5
    v_add_u32 v6, 4294893568, v6
    v_add_u32 v7, 4294893568, v7
    v_add_u32 v8, 4294893568, v8
    v_add_u32 v9, 4294893568, v9
    v_add_u32 v10, 4294893568, v10
    v_add_u32 v11, 4294893568, v11
    v_add_u32 v12, 4294893568, v12
    s_waitcnt lgkmcnt(11)
    v_mfma_f32_32x32x16_bf16 v[192:207], v[168:171], v[104:107], v[192:207]
    ds_read_b128 v[112:115], v5 offset:0
    ds_read_b64_tr_b16 v[144:145], v9 offset:0
    ds_read_b64_tr_b16 v[146:147], v9 offset:512
    s_waitcnt lgkmcnt(12)
    v_mfma_f32_32x32x16_bf16 v[208:223], v[172:175], v[104:107], v[208:223]
    ds_read_b64_tr_b16 v[148:149], v10 offset:0
    ds_read_b64_tr_b16 v[150:151], v10 offset:512
    ds_read_b64_tr_b16 v[160:161], v11 offset:0
    s_waitcnt lgkmcnt(10)
    v_mfma_f32_32x32x16_bf16 v[192:207], v[176:179], v[108:111], v[192:207]
    ds_read_b64_tr_b16 v[162:163], v11 offset:512
    ds_read_b128 v[116:119], v6 offset:0
    ds_read_b64_tr_b16 v[152:153], v9 offset:2048
    s_waitcnt lgkmcnt(11)
    v_mfma_f32_32x32x16_bf16 v[208:223], v[180:183], v[108:111], v[208:223]
    ds_read_b64_tr_b16 v[154:155], v9 offset:2560
    ds_read_b64_tr_b16 v[156:157], v10 offset:2048
    ds_read_b64_tr_b16 v[158:159], v10 offset:2560
    v_mfma_f32_4x4x4_16b_bf16 v[224:227], v[104:105], v[104:105], v[224:227]
    v_mfma_f32_4x4x4_16b_bf16 v[232:235], v[24:25], v[104:105], v[232:235]
    v_mfma_f32_4x4x4_16b_bf16 v[228:231], v[106:107], v[106:107], v[228:231]
    v_mfma_f32_4x4x4_16b_bf16 v[236:239], v[24:25], v[106:107], v[236:239]
    v_mfma_f32_4x4x4_16b_bf16 v[224:227], v[108:109], v[108:109], v[224:227]
    v_mfma_f32_4x4x4_16b_bf16 v[232:235], v[24:25], v[108:109], v[232:235]
    v_mfma_f32_4x4x4_16b_bf16 v[228:231], v[110:111], v[110:111], v[228:231]
    v_mfma_f32_4x4x4_16b_bf16 v[236:239], v[24:25], v[110:111], v[236:239]
    v_mfma_f32_16x16x32_bf16 v[240:243], v[24:27], v[184:187], v[240:243]
    ds_read_b64_tr_b16 v[164:165], v12 offset:0
    s_waitcnt lgkmcnt(13)
    v_mfma_f32_16x16x32_bf16 v[244:247], v[24:27], v[188:191], v[244:247]
    ds_read_b64_tr_b16 v[166:167], v12 offset:512
    s_waitcnt lgkmcnt(11)
    v_mfma_f32_32x32x16_bf16 v[192:207], v[144:147], v[112:115], v[192:207]
    ds_read_b128 v[120:123], v7 offset:0
    ds_read_b64_tr_b16 v[168:169], v9 offset:4096
    ds_read_b64_tr_b16 v[170:171], v9 offset:4608
    s_waitcnt lgkmcnt(12)
    v_mfma_f32_32x32x16_bf16 v[208:223], v[148:151], v[112:115], v[208:223]
    ds_read_b64_tr_b16 v[172:173], v10 offset:4096
    ds_read_b64_tr_b16 v[174:175], v10 offset:4608
    ds_read_b64_tr_b16 v[184:185], v11 offset:4096
    s_waitcnt lgkmcnt(10)
    v_mfma_f32_32x32x16_bf16 v[192:207], v[152:155], v[116:119], v[192:207]
    ds_read_b64_tr_b16 v[186:187], v11 offset:4608
    ds_read_b128 v[124:127], v8 offset:0
    ds_read_b64_tr_b16 v[176:177], v9 offset:6144
    s_waitcnt lgkmcnt(11)
    v_mfma_f32_32x32x16_bf16 v[208:223], v[156:159], v[116:119], v[208:223]
    ds_read_b64_tr_b16 v[178:179], v9 offset:6656
    ds_read_b64_tr_b16 v[180:181], v10 offset:6144
    ds_read_b64_tr_b16 v[182:183], v10 offset:6656
    v_mfma_f32_4x4x4_16b_bf16 v[224:227], v[112:113], v[112:113], v[224:227]
    v_mfma_f32_4x4x4_16b_bf16 v[232:235], v[24:25], v[112:113], v[232:235]
    v_mfma_f32_4x4x4_16b_bf16 v[228:231], v[114:115], v[114:115], v[228:231]
    v_mfma_f32_4x4x4_16b_bf16 v[236:239], v[24:25], v[114:115], v[236:239]
    v_mfma_f32_4x4x4_16b_bf16 v[224:227], v[116:117], v[116:117], v[224:227]
    v_mfma_f32_4x4x4_16b_bf16 v[232:235], v[24:25], v[116:117], v[232:235]
    v_mfma_f32_4x4x4_16b_bf16 v[228:231], v[118:119], v[118:119], v[228:231]
    v_mfma_f32_4x4x4_16b_bf16 v[236:239], v[24:25], v[118:119], v[236:239]
    v_mfma_f32_16x16x32_bf16 v[240:243], v[24:27], v[160:163], v[240:243]
    ds_read_b64_tr_b16 v[188:189], v12 offset:4096
    s_waitcnt lgkmcnt(13)
    v_mfma_f32_16x16x32_bf16 v[244:247], v[24:27], v[164:167], v[244:247]
    ds_read_b64_tr_b16 v[190:191], v12 offset:4608
    s_barrier
    s_waitcnt lgkmcnt(11)
    v_mfma_f32_32x32x16_bf16 v[192:207], v[168:171], v[120:123], v[192:207]
    ds_read_b128 v[128:131], v5 offset:24576
    ds_read_b64_tr_b16 v[144:145], v9 offset:24576
    ds_read_b64_tr_b16 v[146:147], v9 offset:25088
    s_waitcnt lgkmcnt(12)
    v_mfma_f32_32x32x16_bf16 v[208:223], v[172:175], v[120:123], v[208:223]
    ds_read_b64_tr_b16 v[148:149], v10 offset:24576
    ds_read_b64_tr_b16 v[150:151], v10 offset:25088
    ds_read_b64_tr_b16 v[160:161], v11 offset:24576
    s_waitcnt lgkmcnt(10)
    v_mfma_f32_32x32x16_bf16 v[192:207], v[176:179], v[124:127], v[192:207]
    ds_read_b64_tr_b16 v[162:163], v11 offset:25088
    ds_read_b128 v[132:135], v6 offset:24576
    ds_read_b64_tr_b16 v[152:153], v9 offset:26624
    s_waitcnt lgkmcnt(11)
    v_mfma_f32_32x32x16_bf16 v[208:223], v[180:183], v[124:127], v[208:223]
    ds_read_b64_tr_b16 v[154:155], v9 offset:27136
    ds_read_b64_tr_b16 v[156:157], v10 offset:26624
    ds_read_b64_tr_b16 v[158:159], v10 offset:27136
    v_mfma_f32_4x4x4_16b_bf16 v[224:227], v[120:121], v[120:121], v[224:227]
    v_mfma_f32_4x4x4_16b_bf16 v[232:235], v[24:25], v[120:121], v[232:235]
    v_mfma_f32_4x4x4_16b_bf16 v[228:231], v[122:123], v[122:123], v[228:231]
    v_mfma_f32_4x4x4_16b_bf16 v[236:239], v[24:25], v[122:123], v[236:239]
    v_mfma_f32_4x4x4_16b_bf16 v[224:227], v[124:125], v[124:125], v[224:227]
    v_mfma_f32_4x4x4_16b_bf16 v[232:235], v[24:25], v[124:125], v[232:235]
    v_mfma_f32_4x4x4_16b_bf16 v[228:231], v[126:127], v[126:127], v[228:231]
    v_mfma_f32_4x4x4_16b_bf16 v[236:239], v[24:25], v[126:127], v[236:239]
    v_mfma_f32_16x16x32_bf16 v[240:243], v[24:27], v[184:187], v[240:243]
    ds_read_b64_tr_b16 v[164:165], v12 offset:24576
    s_waitcnt lgkmcnt(13)
    v_mfma_f32_16x16x32_bf16 v[244:247], v[24:27], v[188:191], v[244:247]
    ds_read_b64_tr_b16 v[166:167], v12 offset:25088
    s_waitcnt lgkmcnt(11)
    v_mfma_f32_32x32x16_bf16 v[192:207], v[144:147], v[128:131], v[192:207]
    ds_read_b128 v[136:139], v7 offset:24576
    ds_read_b64_tr_b16 v[168:169], v9 offset:28672
    ds_read_b64_tr_b16 v[170:171], v9 offset:29184
    s_waitcnt lgkmcnt(12)
    v_mfma_f32_32x32x16_bf16 v[208:223], v[148:151], v[128:131], v[208:223]
    ds_read_b64_tr_b16 v[172:173], v10 offset:28672
    ds_read_b64_tr_b16 v[174:175], v10 offset:29184
    ds_read_b64_tr_b16 v[184:185], v11 offset:28672
    s_waitcnt lgkmcnt(10)
    v_mfma_f32_32x32x16_bf16 v[192:207], v[152:155], v[132:135], v[192:207]
    ds_read_b64_tr_b16 v[186:187], v11 offset:29184
    ds_read_b128 v[140:143], v8 offset:24576
    ds_read_b64_tr_b16 v[176:177], v9 offset:30720
    s_waitcnt lgkmcnt(11)
    v_mfma_f32_32x32x16_bf16 v[208:223], v[156:159], v[132:135], v[208:223]
    ds_read_b64_tr_b16 v[178:179], v9 offset:31232
    ds_read_b64_tr_b16 v[180:181], v10 offset:30720
    ds_read_b64_tr_b16 v[182:183], v10 offset:31232
    v_mfma_f32_4x4x4_16b_bf16 v[224:227], v[128:129], v[128:129], v[224:227]
    v_mfma_f32_4x4x4_16b_bf16 v[232:235], v[24:25], v[128:129], v[232:235]
    v_mfma_f32_4x4x4_16b_bf16 v[228:231], v[130:131], v[130:131], v[228:231]
    v_mfma_f32_4x4x4_16b_bf16 v[236:239], v[24:25], v[130:131], v[236:239]
    v_mfma_f32_4x4x4_16b_bf16 v[224:227], v[132:133], v[132:133], v[224:227]
    v_mfma_f32_4x4x4_16b_bf16 v[232:235], v[24:25], v[132:133], v[232:235]
    v_mfma_f32_4x4x4_16b_bf16 v[228:231], v[134:135], v[134:135], v[228:231]
    v_mfma_f32_4x4x4_16b_bf16 v[236:239], v[24:25], v[134:135], v[236:239]
    v_mfma_f32_16x16x32_bf16 v[240:243], v[24:27], v[160:163], v[240:243]
    ds_read_b64_tr_b16 v[188:189], v12 offset:28672
    s_waitcnt lgkmcnt(13)
    v_mfma_f32_16x16x32_bf16 v[244:247], v[24:27], v[164:167], v[244:247]
    ds_read_b64_tr_b16 v[190:191], v12 offset:29184
    s_mov_b32 s32, s68
    s_mov_b32 s33, s69
    s_mov_b32 s34, 256
    s_mov_b32 s35, 0x20000
    v_mov_b32 v248, 0
    buffer_load_dword v249, v248, s[32:35], 0 offen sc1
    s_waitcnt lgkmcnt(11)
    v_mfma_f32_32x32x16_bf16 v[192:207], v[168:171], v[136:139], v[192:207]
    s_waitcnt lgkmcnt(9)
    v_mfma_f32_32x32x16_bf16 v[208:223], v[172:175], v[136:139], v[208:223]
    s_waitcnt lgkmcnt(4)
    v_mfma_f32_32x32x16_bf16 v[192:207], v[176:179], v[140:143], v[192:207]
    s_waitcnt lgkmcnt(2)
    v_mfma_f32_32x32x16_bf16 v[208:223], v[180:183], v[140:143], v[208:223]
    v_mfma_f32_4x4x4_16b_bf16 v[224:227], v[136:137], v[136:137], v[224:227]
    v_mfma_f32_4x4x4_16b_bf16 v[232:235], v[24:25], v[136:137], v[232:235]
    v_mfma_f32_4x4x4_16b_bf16 v[228:231], v[138:139], v[138:139], v[228:231]
    v_mfma_f32_4x4x4_16b_bf16 v[236:239], v[24:25], v[138:139], v[236:239]
    v_mfma_f32_4x4x4_16b_bf16 v[224:227], v[140:141], v[140:141], v[224:227]
    v_mfma_f32_4x4x4_16b_bf16 v[232:235], v[24:25], v[140:141], v[232:235]
    v_mfma_f32_4x4x4_16b_bf16 v[228:231], v[142:143], v[142:143], v[228:231]
    v_mfma_f32_4x4x4_16b_bf16 v[236:239], v[24:25], v[142:143], v[236:239]
    v_mfma_f32_16x16x32_bf16 v[240:243], v[24:27], v[184:187], v[240:243]
    s_waitcnt lgkmcnt(0)
    v_mfma_f32_16x16x32_bf16 v[244:247], v[24:27], v[188:191], v[244:247]
    s_nop 5
    ds_write_b32 v18, v240
    s_nop 0
    ds_write_b32 v18, v244 offset:64
    v_add_f32 v224, v224, v228
    v_add_f32 v225, v225, v229
    v_add_f32 v226, v226, v230
    v_add_f32 v227, v227, v231
    v_add_f32 v28, v232, v236
    v_cndmask_b32 v224, v224, v225, s[24:25]
    v_cndmask_b32 v224, v224, v226, s[26:27]
    v_cndmask_b32 v29, v224, v227, s[28:29]
    v_mov_b32 v250, v28
    v_mov_b32 v251, v29
    s_nop 0
    v_permlane32_swap_b32 v28, v250
    v_permlane32_swap_b32 v29, v251
    v_add_f32 v28, v28, v250
    v_add_f32 v29, v29, v251
    s_waitcnt lgkmcnt(0)
    s_barrier
    ds_read_b128 v[144:147], v19 offset:0
    ds_read_b128 v[148:151], v19 offset:32
    ds_read_b128 v[152:155], v19 offset:64
    ds_read_b128 v[156:159], v19 offset:96
    ds_read_b128 v[160:163], v19 offset:128
    ds_read_b128 v[164:167], v19 offset:160
    ds_read_b128 v[168:171], v19 offset:192
    ds_read_b128 v[172:175], v19 offset:224
    v_mul_f32 v28, 0xbb124925, v28
    v_mul_f32 v29, 0x3b124925, v29
    v_fma_f32 v29, -v28, v28, v29
    v_max_f32 v29, 0, v29
    v_add_f32 v29, 0x3727c5ac, v29
    v_rsq_f32 v29, v29
    s_waitcnt lgkmcnt(4)
    v_pk_fma_f32 v[192:193], v[144:145], v[28:29], v[192:193] op_sel_hi:[1,0,1]
    v_pk_fma_f32 v[194:195], v[146:147], v[28:29], v[194:195] op_sel_hi:[1,0,1]
    v_pk_fma_f32 v[196:197], v[148:149], v[28:29], v[196:197] op_sel_hi:[1,0,1]
    v_pk_fma_f32 v[198:199], v[150:151], v[28:29], v[198:199] op_sel_hi:[1,0,1]
    v_pk_mul_f32 v[192:193], v[192:193], v[28:29] op_sel:[0,1] op_sel_hi:[1,1]
    v_pk_mul_f32 v[194:195], v[194:195], v[28:29] op_sel:[0,1] op_sel_hi:[1,1]
    v_pk_mul_f32 v[196:197], v[196:197], v[28:29] op_sel:[0,1] op_sel_hi:[1,1]
    v_pk_mul_f32 v[198:199], v[198:199], v[28:29] op_sel:[0,1] op_sel_hi:[1,1]
    v_cvt_pk_bf16_f32 v176, v192, v193
    v_cvt_pk_bf16_f32 v177, v194, v195
    v_cvt_pk_bf16_f32 v178, v196, v197
    v_cvt_pk_bf16_f32 v179, v198, v199
    buffer_store_dwordx4 v[176:179], v17, s[72:75], s60 offen offset:0 sc1
    v_pk_fma_f32 v[200:201], v[152:153], v[28:29], v[200:201] op_sel_hi:[1,0,1]
    v_pk_fma_f32 v[202:203], v[154:155], v[28:29], v[202:203] op_sel_hi:[1,0,1]
    v_pk_fma_f32 v[204:205], v[156:157], v[28:29], v[204:205] op_sel_hi:[1,0,1]
    v_pk_fma_f32 v[206:207], v[158:159], v[28:29], v[206:207] op_sel_hi:[1,0,1]
    v_pk_mul_f32 v[200:201], v[200:201], v[28:29] op_sel:[0,1] op_sel_hi:[1,1]
    v_pk_mul_f32 v[202:203], v[202:203], v[28:29] op_sel:[0,1] op_sel_hi:[1,1]
    v_pk_mul_f32 v[204:205], v[204:205], v[28:29] op_sel:[0,1] op_sel_hi:[1,1]
    v_pk_mul_f32 v[206:207], v[206:207], v[28:29] op_sel:[0,1] op_sel_hi:[1,1]
    v_cvt_pk_bf16_f32 v180, v200, v201
    v_cvt_pk_bf16_f32 v181, v202, v203
    v_cvt_pk_bf16_f32 v182, v204, v205
    v_cvt_pk_bf16_f32 v183, v206, v207
    v_cndmask_b32 v182, v182, v23, s[30:31]
    v_cndmask_b32 v183, v183, 0, s[30:31]
    buffer_store_dwordx4 v[180:183], v17, s[72:75], s60 offen offset:1024 sc1
    s_waitcnt lgkmcnt(0)
    s_add_u32 s60, s60, 147456
    v_pk_fma_f32 v[208:209], v[160:161], v[28:29], v[208:209] op_sel_hi:[1,0,1]
    v_pk_fma_f32 v[210:211], v[162:163], v[28:29], v[210:211] op_sel_hi:[1,0,1]
    v_pk_fma_f32 v[212:213], v[164:165], v[28:29], v[212:213] op_sel_hi:[1,0,1]
    v_pk_fma_f32 v[214:215], v[166:167], v[28:29], v[214:215] op_sel_hi:[1,0,1]
    v_pk_mul_f32 v[208:209], v[208:209], v[28:29] op_sel:[0,1] op_sel_hi:[1,1]
    v_pk_mul_f32 v[210:211], v[210:211], v[28:29] op_sel:[0,1] op_sel_hi:[1,1]
    v_pk_mul_f32 v[212:213], v[212:213], v[28:29] op_sel:[0,1] op_sel_hi:[1,1]
    v_pk_mul_f32 v[214:215], v[214:215], v[28:29] op_sel:[0,1] op_sel_hi:[1,1]
    v_cvt_pk_bf16_f32 v184, v208, v209
    v_cvt_pk_bf16_f32 v185, v210, v211
    v_cvt_pk_bf16_f32 v186, v212, v213
    v_cvt_pk_bf16_f32 v187, v214, v215
    buffer_store_dwordx4 v[184:187], v17, s[72:75], s60 offen offset:0 sc1
    v_pk_fma_f32 v[216:217], v[168:169], v[28:29], v[216:217] op_sel_hi:[1,0,1]
    v_pk_fma_f32 v[218:219], v[170:171], v[28:29], v[218:219] op_sel_hi:[1,0,1]
    v_pk_fma_f32 v[220:221], v[172:173], v[28:29], v[220:221] op_sel_hi:[1,0,1]
    v_pk_fma_f32 v[222:223], v[174:175], v[28:29], v[222:223] op_sel_hi:[1,0,1]
    v_pk_mul_f32 v[216:217], v[216:217], v[28:29] op_sel:[0,1] op_sel_hi:[1,1]
    v_pk_mul_f32 v[218:219], v[218:219], v[28:29] op_sel:[0,1] op_sel_hi:[1,1]
    v_pk_mul_f32 v[220:221], v[220:221], v[28:29] op_sel:[0,1] op_sel_hi:[1,1]
    v_pk_mul_f32 v[222:223], v[222:223], v[28:29] op_sel:[0,1] op_sel_hi:[1,1]
    v_cvt_pk_bf16_f32 v188, v216, v217
    v_cvt_pk_bf16_f32 v189, v218, v219
    v_cvt_pk_bf16_f32 v190, v220, v221
    v_cvt_pk_bf16_f32 v191, v222, v223
    v_cndmask_b32 v190, v190, v23, s[30:31]
    v_cndmask_b32 v191, v191, 0, s[30:31]
    buffer_store_dwordx4 v[188:191], v17, s[72:75], s60 offen offset:1024 sc1
    v_lshlrev_b32 v8, 4, v1
    v_lshrrev_b32 v2, 5, v1
    v_and_b32 v3, 31, v1
    v_mov_b32 v10, 0xf149f2ca
    v_lshlrev_b32 v11, 2, v2
    v_sub_u32 v11, v3, v11
    v_cmp_gt_i32 vcc, 0, v11
    s_nop 1
    v_cndmask_b32 v172, v10, 0, vcc
    v_cndmask_b32 v188, 0, v10, vcc
    v_cmp_gt_i32 vcc, 1, v11
    s_nop 1
    v_cndmask_b32 v173, v10, 0, vcc
    v_cndmask_b32 v189, 0, v10, vcc
    v_cmp_gt_i32 vcc, 2, v11
    s_nop 1
    v_cndmask_b32 v174, v10, 0, vcc
    v_cndmask_b32 v190, 0, v10, vcc
    v_cmp_gt_i32 vcc, 3, v11
    s_nop 1
    v_cndmask_b32 v175, v10, 0, vcc
    v_cndmask_b32 v191, 0, v10, vcc
    v_cmp_gt_i32 vcc, 8, v11
    s_nop 1
    v_cndmask_b32 v176, v10, 0, vcc
    v_cndmask_b32 v192, 0, v10, vcc
    v_cmp_gt_i32 vcc, 9, v11
    s_nop 1
    v_cndmask_b32 v177, v10, 0, vcc
    v_cndmask_b32 v193, 0, v10, vcc
    v_cmp_gt_i32 vcc, 10, v11
    s_nop 1
    v_cndmask_b32 v178, v10, 0, vcc
    v_cndmask_b32 v194, 0, v10, vcc
    v_cmp_gt_i32 vcc, 11, v11
    s_nop 1
    v_cndmask_b32 v179, v10, 0, vcc
    v_cndmask_b32 v195, 0, v10, vcc
    v_cmp_gt_i32 vcc, 16, v11
    s_nop 1
    v_cndmask_b32 v180, v10, 0, vcc
    v_cndmask_b32 v196, 0, v10, vcc
    v_cmp_gt_i32 vcc, 17, v11
    s_nop 1
    v_cndmask_b32 v181, v10, 0, vcc
    v_cndmask_b32 v197, 0, v10, vcc
    v_cmp_gt_i32 vcc, 18, v11
    s_nop 1
    v_cndmask_b32 v182, v10, 0, vcc
    v_cndmask_b32 v198, 0, v10, vcc
    v_cmp_gt_i32 vcc, 19, v11
    s_nop 1
    v_cndmask_b32 v183, v10, 0, vcc
    v_cndmask_b32 v199, 0, v10, vcc
    v_cmp_gt_i32 vcc, 24, v11
    s_nop 1
    v_cndmask_b32 v184, v10, 0, vcc
    v_cndmask_b32 v200, 0, v10, vcc
    v_cmp_gt_i32 vcc, 25, v11
    s_nop 1
    v_cndmask_b32 v185, v10, 0, vcc
    v_cndmask_b32 v201, 0, v10, vcc
    v_cmp_gt_i32 vcc, 26, v11
    s_nop 1
    v_cndmask_b32 v186, v10, 0, vcc
    v_cndmask_b32 v202, 0, v10, vcc
    v_cmp_gt_i32 vcc, 27, v11
    s_nop 1
    v_cndmask_b32 v187, v10, 0, vcc
    v_cndmask_b32 v203, 0, v10, vcc
    s_lshl_b32 s47, s36, 11
    v_add_u32 v9, s47, v8
    v_bfe_u32 v4, v1, 4, 1
    v_and_b32 v5, 1, v1
    v_lshl_add_u32 v10, v4, 1, v5
    v_xor_b32 v10, v10, v2
    v_lshl_add_u32 v10, v5, 3, v10
    v_lshlrev_b32 v10, 6, v10
    v_lshl_add_u32 v10, v4, 10, v10
    v_bfe_u32 v4, v1, 2, 2
    v_lshl_add_u32 v10, v4, 4, v10
    v_bfe_u32 v4, v1, 1, 1
    v_lshl_add_u32 v10, v4, 3, v10
    s_add_u32 s47, s47, 24576
    v_add_u32 v6, s47, v10
    v_xor_b32 v7, 128, v6
    s_lshl_b32 s46, s37, 2
    s_add_u32 s46, s46, s36
    s_mul_i32 s42, s46, 32
    s_lshl_b32 s47, s38, 1
    s_add_u32 s42, s42, s47
    s_lshl_b32 s42, s42, 10
    s_add_u32 s42, s42, 0
    v_mov_b32 v11, 61769
    s_lshl_b32 s61, s37, 4
    s_add_u32 s61, s61, s38
    s_lshl_b32 s61, s61, 8
    s_add_u32 s61, s61, 37879808
    s_waitcnt vmcnt(4)
    v_readfirstlane_b32 s63, v249
    s_nop 0
    s_cmp_lg_u32 s63, 0
    s_cbranch_scc1 mk_epok
    s_mov_b32 s32, s68
    s_mov_b32 s33, s69
    s_mov_b32 s34, 256
    s_mov_b32 s35, 0x20000
    v_mov_b32 v248, 0
    s_mov_b32 s62, 0
mk_8:
    buffer_load_dword v249, v248, s[32:35], 0 offen sc1
    s_waitcnt vmcnt(0)
    v_readfirstlane_b32 s63, v249
    s_add_u32 s62, s62, 1
    s_cmp_lg_u32 s63, 0
    s_cbranch_scc1 mk_8d
    s_sleep 2
    s_cmp_lt_u32 s62, 131072
    s_cbranch_scc1 mk_8
mk_8d:
mk_epok:
    v_mov_b32 v204, 163836
    v_mov_b32 v205, 1
    s_mov_b64 exec, 1
    s_waitcnt vmcnt(0)
    ds_add_rtn_u32 v205, v204, v205
    s_waitcnt lgkmcnt(0)
    v_readfirstlane_b32 s62, v205
    s_nop 0
    s_and_b32 s62, s62, 3
    s_cmp_lg_u32 s62, 3
    s_cbranch_scc1 mk_9
    v_mov_b32 v204, 0
    v_mov_b32 v205, s63
    buffer_store_dword v205, v204, s[72:75], s51 offen sc1
mk_9:
    s_mov_b64 exec, -1
    s_barrier
    ds_read_b64_tr_b16 v[144:145], v31 offset:0
    ds_read_b64_tr_b16 v[146:147], v31 offset:256
    ds_read_b64_tr_b16 v[148:149], v31 offset:1024
    ds_read_b64_tr_b16 v[150:151], v31 offset:1280
    ds_read_b64_tr_b16 v[152:153], v31 offset:2048
    ds_read_b64_tr_b16 v[154:155], v31 offset:2304
    ds_read_b64_tr_b16 v[156:157], v31 offset:3072
    ds_read_b64_tr_b16 v[158:159], v31 offset:3328
    ds_read_b64_tr_b16 v[160:161], v31 offset:4096
    ds_read_b64_tr_b16 v[162:163], v31 offset:4352
    s_waitcnt lgkmcnt(8)
    v_mfma_f32_32x32x16_bf16 v[224:239], v[144:147], v[32:35], 0
    ds_read_b64_tr_b16 v[164:165], v31 offset:5120
    ds_read_b64_tr_b16 v[166:167], v31 offset:5376
    v_mfma_f32_4x4x4_16b_bf16 v[208:211], v[24:25], v[144:145], 0
    v_mfma_f32_4x4x4_16b_bf16 v[212:215], v[24:25], v[146:147], 0
    s_waitcnt lgkmcnt(8)
    v_mfma_f32_32x32x16_bf16 v[224:239], v[148:151], v[36:39], v[224:239]
    ds_read_b64_tr_b16 v[168:169], v31 offset:6144
    ds_read_b64_tr_b16 v[170:171], v31 offset:6400
    v_mfma_f32_4x4x4_16b_bf16 v[208:211], v[24:25], v[148:149], v[208:211]
    v_mfma_f32_4x4x4_16b_bf16 v[212:215], v[24:25], v[150:151], v[212:215]
    s_waitcnt lgkmcnt(8)
    v_mfma_f32_32x32x16_bf16 v[224:239], v[152:155], v[40:43], v[224:239]
    ds_read_b64_tr_b16 v[144:145], v31 offset:7168
    ds_read_b64_tr_b16 v[146:147], v31 offset:7424
    v_mfma_f32_4x4x4_16b_bf16 v[208:211], v[24:25], v[152:153], v[208:211]
    v_mfma_f32_4x4x4_16b_bf16 v[212:215], v[24:25], v[154:155], v[212:215]
    s_waitcnt lgkmcnt(8)
    v_mfma_f32_32x32x16_bf16 v[224:239], v[156:159], v[44:47], v[224:239]
    ds_read_b64_tr_b16 v[148:149], v31 offset:8192
    ds_read_b64_tr_b16 v[150:151], v31 offset:8448
    v_mfma_f32_4x4x4_16b_bf16 v[208:211], v[24:25], v[156:157], v[208:211]
    v_mfma_f32_4x4x4_16b_bf16 v[212:215], v[24:25], v[158:159], v[212:215]
    s_waitcnt lgkmcnt(8)
    v_mfma_f32_32x32x16_bf16 v[224:239], v[160:163], v[48:51], v[224:239]
    ds_read_b64_tr_b16 v[152:153], v31 offset:9216
    ds_read_b64_tr_b16 v[154:155], v31 offset:9472
    v_mfma_f32_4x4x4_16b_bf16 v[208:211], v[24:25], v[160:161], v[208:211]
    v_mfma_f32_4x4x4_16b_bf16 v[212:215], v[24:25], v[162:163], v[212:215]
    s_waitcnt lgkmcnt(8)
    v_mfma_f32_32x32x16_bf16 v[224:239], v[164:167], v[52:55], v[224:239]
    ds_read_b64_tr_b16 v[156:157], v31 offset:10240
    ds_read_b64_tr_b16 v[158:159], v31 offset:10496
    v_mfma_f32_4x4x4_16b_bf16 v[208:211], v[24:25], v[164:165], v[208:211]
    v_mfma_f32_4x4x4_16b_bf16 v[212:215], v[24:25], v[166:167], v[212:215]
    s_waitcnt lgkmcnt(8)
    v_mfma_f32_32x32x16_bf16 v[224:239], v[168:171], v[56:59], v[224:239]
    ds_read_b64_tr_b16 v[160:161], v31 offset:11264
    ds_read_b64_tr_b16 v[162:163], v31 offset:11520
    v_mfma_f32_4x4x4_16b_bf16 v[208:211], v[24:25], v[168:169], v[208:211]
    v_mfma_f32_4x4x4_16b_bf16 v[212:215], v[24:25], v[170:171], v[212:215]
    s_waitcnt lgkmcnt(8)
    v_mfma_f32_32x32x16_bf16 v[224:239], v[144:147], v[60:63], v[224:239]
    ds_read_b64_tr_b16 v[164:165], v31 offset:12288
    ds_read_b64_tr_b16 v[166:167], v31 offset:12544
    v_mfma_f32_4x4x4_16b_bf16 v[208:211], v[24:25], v[144:145], v[208:211]
    v_mfma_f32_4x4x4_16b_bf16 v[212:215], v[24:25], v[146:147], v[212:215]
    s_waitcnt lgkmcnt(8)
    v_mfma_f32_32x32x16_bf16 v[224:239], v[148:151], v[64:67], v[224:239]
    ds_read_b64_tr_b16 v[168:169], v31 offset:13312
    ds_read_b64_tr_b16 v[170:171], v31 offset:13568
    v_mfma_f32_4x4x4_16b_bf16 v[208:211], v[24:25], v[148:149], v[208:211]
    v_mfma_f32_4x4x4_16b_bf16 v[212:215], v[24:25], v[150:151], v[212:215]
    s_waitcnt lgkmcnt(8)
    v_mfma_f32_32x32x16_bf16 v[224:239], v[152:155], v[68:71], v[224:239]
    ds_read_b64_tr_b16 v[144:145], v31 offset:14336
    ds_read_b64_tr_b16 v[146:147], v31 offset:14592
    v_mfma_f32_4x4x4_16b_bf16 v[208:211], v[24:25], v[152:153], v[208:211]
    v_mfma_f32_4x4x4_16b_bf16 v[212:215], v[24:25], v[154:155], v[212:215]
    s_waitcnt lgkmcnt(8)
    v_mfma_f32_32x32x16_bf16 v[224:239], v[156:159], v[72:75], v[224:239]
    ds_read_b64_tr_b16 v[148:149], v31 offset:15360
    ds_read_b64_tr_b16 v[150:151], v31 offset:15616
    v_mfma_f32_4x4x4_16b_bf16 v[208:211], v[24:25], v[156:157], v[208:211]
    v_mfma_f32_4x4x4_16b_bf16 v[212:215], v[24:25], v[158:159], v[212:215]
    s_waitcnt lgkmcnt(8)
    v_mfma_f32_32x32x16_bf16 v[224:239], v[160:163], v[76:79], v[224:239]
    ds_read_b64_tr_b16 v[152:153], v31 offset:16384
    ds_read_b64_tr_b16 v[154:155], v31 offset:16640
    v_mfma_f32_4x4x4_16b_bf16 v[208:211], v[24:25], v[160:161], v[208:211]
    v_mfma_f32_4x4x4_16b_bf16 v[212:215], v[24:25], v[162:163], v[212:215]
    s_waitcnt lgkmcnt(8)
    v_mfma_f32_32x32x16_bf16 v[224:239], v[164:167], v[80:83], v[224:239]
    ds_read_b64_tr_b16 v[156:157], v31 offset:17408
    ds_read_b64_tr_b16 v[158:159], v31 offset:17664
    v_mfma_f32_4x4x4_16b_bf16 v[208:211], v[24:25], v[164:165], v[208:211]
    v_mfma_f32_4x4x4_16b_bf16 v[212:215], v[24:25], v[166:167], v[212:215]
    s_waitcnt lgkmcnt(8)
    v_mfma_f32_32x32x16_bf16 v[224:239], v[168:171], v[84:87], v[224:239]
    ds_read_b64_tr_b16 v[160:161], v31 offset:18432
    ds_read_b64_tr_b16 v[162:163], v31 offset:18688
    v_mfma_f32_4x4x4_16b_bf16 v[208:211], v[24:25], v[168:169], v[208:211]
    v_mfma_f32_4x4x4_16b_bf16 v[212:215], v[24:25], v[170:171], v[212:215]
    s_waitcnt lgkmcnt(8)
    v_mfma_f32_32x32x16_bf16 v[224:239], v[144:147], v[88:91], v[224:239]
    ds_read_b64_tr_b16 v[164:165], v31 offset:19456
    ds_read_b64_tr_b16 v[166:167], v31 offset:19712
    v_mfma_f32_4x4x4_16b_bf16 v[208:211], v[24:25], v[144:145], v[208:211]
    v_mfma_f32_4x4x4_16b_bf16 v[212:215], v[24:25], v[146:147], v[212:215]
    s_waitcnt lgkmcnt(8)
    v_mfma_f32_32x32x16_bf16 v[224:239], v[148:151], v[92:95], v[224:239]
    ds_read_b64_tr_b16 v[168:169], v31 offset:20480
    ds_read_b64_tr_b16 v[170:171], v31 offset:20736
    v_mfma_f32_4x4x4_16b_bf16 v[208:211], v[24:25], v[148:149], v[208:211]
    v_mfma_f32_4x4x4_16b_bf16 v[212:215], v[24:25], v[150:151], v[212:215]
    s_waitcnt lgkmcnt(8)
    v_mfma_f32_32x32x16_bf16 v[224:239], v[152:155], v[96:99], v[224:239]
    ds_read_b64_tr_b16 v[144:145], v31 offset:21504
    ds_read_b64_tr_b16 v[146:147], v31 offset:21760
    v_mfma_f32_4x4x4_16b_bf16 v[208:211], v[24:25], v[152:153], v[208:211]
    v_mfma_f32_4x4x4_16b_bf16 v[212:215], v[24:25], v[154:155], v[212:215]
    s_waitcnt lgkmcnt(8)
    v_mfma_f32_32x32x16_bf16 v[224:239], v[156:159], v[100:103], v[224:239]
    ds_read_b64_tr_b16 v[148:149], v31 offset:22528
    ds_read_b64_tr_b16 v[150:151], v31 offset:22784
    v_mfma_f32_4x4x4_16b_bf16 v[208:211], v[24:25], v[156:157], v[208:211]
    v_mfma_f32_4x4x4_16b_bf16 v[212:215], v[24:25], v[158:159], v[212:215]
    s_waitcnt lgkmcnt(8)
    v_mfma_f32_32x32x16_bf16 v[224:239], v[160:163], v[104:107], v[224:239]
    ds_read_b64_tr_b16 v[152:153], v31 offset:23552
    ds_read_b64_tr_b16 v[154:155], v31 offset:23808
    v_mfma_f32_4x4x4_16b_bf16 v[208:211], v[24:25], v[160:161], v[208:211]
    v_mfma_f32_4x4x4_16b_bf16 v[212:215], v[24:25], v[162:163], v[212:215]
    s_waitcnt lgkmcnt(8)
    v_mfma_f32_32x32x16_bf16 v[224:239], v[164:167], v[108:111], v[224:239]
    ds_read_b64_tr_b16 v[156:157], v31 offset:24576
    ds_read_b64_tr_b16 v[158:159], v31 offset:24832
    v_mfma_f32_4x4x4_16b_bf16 v[208:211], v[24:25], v[164:165], v[208:211]
    v_mfma_f32_4x4x4_16b_bf16 v[212:215], v[24:25], v[166:167], v[212:215]
    s_barrier
    s_waitcnt lgkmcnt(8)
    v_mfma_f32_32x32x16_bf16 v[224:239], v[168:171], v[112:115], v[224:239]
    ds_read_b64_tr_b16 v[160:161], v31 offset:25600
    ds_read_b64_tr_b16 v[162:163], v31 offset:25856
    v_mfma_f32_4x4x4_16b_bf16 v[208:211], v[24:25], v[168:169], v[208:211]
    v_mfma_f32_4x4x4_16b_bf16 v[212:215], v[24:25], v[170:171], v[212:215]
    s_waitcnt lgkmcnt(8)
    v_mfma_f32_32x32x16_bf16 v[224:239], v[144:147], v[116:119], v[224:239]
    ds_read_b64_tr_b16 v[164:165], v31 offset:26624
    ds_read_b64_tr_b16 v[166:167], v31 offset:26880
    v_mfma_f32_4x4x4_16b_bf16 v[208:211], v[24:25], v[144:145], v[208:211]
    v_mfma_f32_4x4x4_16b_bf16 v[212:215], v[24:25], v[146:147], v[212:215]
    s_waitcnt lgkmcnt(8)
    v_mfma_f32_32x32x16_bf16 v[224:239], v[148:151], v[120:123], v[224:239]
    ds_read_b64_tr_b16 v[168:169], v31 offset:27648
    ds_read_b64_tr_b16 v[170:171], v31 offset:27904
    v_mfma_f32_4x4x4_16b_bf16 v[208:211], v[24:25], v[148:149], v[208:211]
    v_mfma_f32_4x4x4_16b_bf16 v[212:215], v[24:25], v[150:151], v[212:215]
    s_waitcnt lgkmcnt(8)
    v_mfma_f32_32x32x16_bf16 v[224:239], v[152:155], v[124:127], v[224:239]
    v_mfma_f32_4x4x4_16b_bf16 v[208:211], v[24:25], v[152:153], v[208:211]
    v_mfma_f32_4x4x4_16b_bf16 v[212:215], v[24:25], v[154:155], v[212:215]
    s_waitcnt lgkmcnt(6)
    v_mfma_f32_32x32x16_bf16 v[224:239], v[156:159], v[128:131], v[224:239]
    v_mfma_f32_4x4x4_16b_bf16 v[208:211], v[24:25], v[156:157], v[208:211]
    v_mfma_f32_4x4x4_16b_bf16 v[212:215], v[24:25], v[158:159], v[212:215]
    s_waitcnt lgkmcnt(4)
    v_mfma_f32_32x32x16_bf16 v[224:239], v[160:163], v[132:135], v[224:239]
    v_mfma_f32_4x4x4_16b_bf16 v[208:211], v[24:25], v[160:161], v[208:211]
    v_mfma_f32_4x4x4_16b_bf16 v[212:215], v[24:25], v[162:163], v[212:215]
    s_waitcnt lgkmcnt(2)
    v_mfma_f32_32x32x16_bf16 v[224:239], v[164:167], v[136:139], v[224:239]
    v_mfma_f32_4x4x4_16b_bf16 v[208:211], v[24:25], v[164:165], v[208:211]
    v_mfma_f32_4x4x4_16b_bf16 v[212:215], v[24:25], v[166:167], v[212:215]
    s_waitcnt lgkmcnt(0)
    v_mfma_f32_32x32x16_bf16 v[224:239], v[168:171], v[140:143], v[224:239]
    v_mfma_f32_4x4x4_16b_bf16 v[208:211], v[24:25], v[168:169], v[208:211]
    v_mfma_f32_4x4x4_16b_bf16 v[212:215], v[24:25], v[170:171], v[212:215]
    s_lshl_b32 s54, s36, 7
    v_and_b32 v20, 31, v1
    v_lshlrev_b32 v20, 2, v20
    v_add_u32 v20, s54, v20
    v_add_u32 v20, 152064, v20
    v_add_u32 v21, s54, v19
    v_add_f32 v208, v208, v212
    v_mov_b32 v209, v208
    s_nop 1
    v_permlane32_swap_b32 v208, v209
    v_add_f32 v208, v208, v209
    ds_write_b32 v20, v208
    ds_read_b128 v[240:243], v21 offset:512
    ds_read_b128 v[244:247], v21 offset:544
    ds_read_b128 v[248:251], v21 offset:576
    ds_read_b128 v[252:255], v21 offset:608
    s_waitcnt lgkmcnt(0)
    v_mul_f32 v29, 0x3e8b97f6, v29
    v_mov_b32 v23, 0x3f80
    v_pk_fma_f32 v[224:225], v[240:241], v[28:29], v[224:225] op_sel_hi:[1,0,1]
    v_pk_fma_f32 v[226:227], v[242:243], v[28:29], v[226:227] op_sel_hi:[1,0,1]
    v_pk_fma_f32 v[228:229], v[244:245], v[28:29], v[228:229] op_sel_hi:[1,0,1]
    v_pk_fma_f32 v[230:231], v[246:247], v[28:29], v[230:231] op_sel_hi:[1,0,1]
    v_pk_mul_f32 v[224:225], v[224:225], v[28:29] op_sel:[0,1] op_sel_hi:[1,1]
    v_pk_mul_f32 v[226:227], v[226:227], v[28:29] op_sel:[0,1] op_sel_hi:[1,1]
    v_pk_mul_f32 v[228:229], v[228:229], v[28:29] op_sel:[0,1] op_sel_hi:[1,1]
    v_pk_mul_f32 v[230:231], v[230:231], v[28:29] op_sel:[0,1] op_sel_hi:[1,1]
    v_cvt_pk_bf16_f32 v12, v224, v225
    v_cvt_pk_bf16_f32 v13, v226, v227
    v_cvt_pk_bf16_f32 v14, v228, v229
    v_cvt_pk_bf16_f32 v15, v230, v231
    v_pk_fma_f32 v[232:233], v[248:249], v[28:29], v[232:233] op_sel_hi:[1,0,1]
    v_pk_fma_f32 v[234:235], v[250:251], v[28:29], v[234:235] op_sel_hi:[1,0,1]
    v_pk_fma_f32 v[236:237], v[252:253], v[28:29], v[236:237] op_sel_hi:[1,0,1]
    v_pk_fma_f32 v[238:239], v[254:255], v[28:29], v[238:239] op_sel_hi:[1,0,1]
    v_pk_mul_f32 v[232:233], v[232:233], v[28:29] op_sel:[0,1] op_sel_hi:[1,1]
    v_pk_mul_f32 v[234:235], v[234:235], v[28:29] op_sel:[0,1] op_sel_hi:[1,1]
    v_pk_mul_f32 v[236:237], v[236:237], v[28:29] op_sel:[0,1] op_sel_hi:[1,1]
    v_pk_mul_f32 v[238:239], v[238:239], v[28:29] op_sel:[0,1] op_sel_hi:[1,1]
    v_cvt_pk_bf16_f32 v16, v232, v233
    v_cvt_pk_bf16_f32 v17, v234, v235
    v_cvt_pk_bf16_f32 v18, v236, v237
    v_cvt_pk_bf16_f32 v19, v238, v239
    v_cndmask_b32 v18, v18, v23, s[30:31]
    v_cndmask_b32 v19, v19, 0, s[30:31]
    s_barrier
    s_cmp_ge_u32 s46, 8
    s_cbranch_scc1 mk_p2v
    v_cndmask_b32 v10, 0, v11, s[30:31]
    s_sub_u32 s46, 8, s46
    v_add_u32 v4, 1032, v9
mk_p2i:
    ds_write_b32 v4, v10
    v_add_u32 v4, 2048, v4
    s_sub_u32 s46, s46, 1
    s_cmp_lg_u32 s46, 0
    s_cbranch_scc1 mk_p2i
mk_p2v:
    ds_read_b128 v[20:23], v9 offset:0
    ds_read_b128 v[24:27], v9 offset:1024
    ds_read_b128 v[28:31], v9 offset:2048
    ds_read_b128 v[32:35], v9 offset:3072
    ds_read_b128 v[36:39], v9 offset:4096
    ds_read_b128 v[40:43], v9 offset:5120
    s_waitcnt lgkmcnt(4)
    v_mfma_f32_32x32x16_bf16 v[92:107], v[20:23], v[12:15], v[172:187]
    ds_read_b128 v[44:47], v9 offset:6144
    v_mfma_f32_32x32x16_bf16 v[92:107], v[24:27], v[16:19], v[92:107]
    ds_read_b128 v[48:51], v9 offset:7168
    s_waitcnt lgkmcnt(4)
    v_mfma_f32_32x32x16_bf16 v[108:123], v[28:31], v[12:15], 0
    ds_read_b128 v[52:55], v9 offset:8192
    v_mfma_f32_32x32x16_bf16 v[108:123], v[32:35], v[16:19], v[108:123]
    ds_read_b128 v[56:59], v9 offset:9216
    s_waitcnt lgkmcnt(4)
    v_mfma_f32_32x32x16_bf16 v[124:139], v[36:39], v[12:15], 0
    ds_read_b128 v[60:63], v9 offset:10240
    s_nop 2
    v_max_f32 v4, v92, v93
    v_max_f32 v5, v94, v95
    v_max3_f32 v4, v4, v96, v97
    v_max3_f32 v5, v5, v98, v99
    v_mfma_f32_32x32x16_bf16 v[124:139], v[40:43], v[16:19], v[124:139]
    ds_read_b128 v[64:67], v9 offset:11264
    v_max3_f32 v4, v4, v100, v101
    v_max3_f32 v5, v5, v102, v103
    v_max3_f32 v4, v4, v104, v105
    v_max3_f32 v5, v5, v106, v107
    s_waitcnt lgkmcnt(4)
    v_mfma_f32_32x32x16_bf16 v[92:107], v[44:47], v[12:15], 0
    ds_read_b128 v[68:71], v9 offset:12288
    v_max3_f32 v4, v4, v108, v109
    v_max3_f32 v5, v5, v110, v111
    v_max3_f32 v4, v4, v112, v113
    v_max3_f32 v5, v5, v114, v115
    v_mfma_f32_32x32x16_bf16 v[92:107], v[48:51], v[16:19], v[92:107]
    ds_read_b128 v[72:75], v9 offset:13312
    v_max3_f32 v4, v4, v116, v117
    v_max3_f32 v5, v5, v118, v119
    v_max3_f32 v4, v4, v120, v121
    v_max3_f32 v5, v5, v122, v123
    s_waitcnt lgkmcnt(4)
    v_mfma_f32_32x32x16_bf16 v[108:123], v[52:55], v[12:15], 0
    ds_read_b128 v[76:79], v9 offset:14336
    v_max3_f32 v4, v4, v124, v125
    v_max3_f32 v5, v5, v126, v127
    v_max3_f32 v4, v4, v128, v129
    v_max3_f32 v5, v5, v130, v131
    v_mfma_f32_32x32x16_bf16 v[108:123], v[56:59], v[16:19], v[108:123]
    ds_read_b128 v[80:83], v9 offset:15360
    v_max3_f32 v4, v4, v132, v133
    v_max3_f32 v5, v5, v134, v135
    v_max3_f32 v4, v4, v136, v137
    v_max3_f32 v5, v5, v138, v139
    s_waitcnt lgkmcnt(4)
    v_mfma_f32_32x32x16_bf16 v[124:139], v[60:63], v[12:15], 0
    ds_read_b128 v[84:87], v9 offset:16384
    v_max3_f32 v4, v4, v92, v93
    v_max3_f32 v5, v5, v94, v95
    v_max3_f32 v4, v4, v96, v97
    v_max3_f32 v5, v5, v98, v99
    v_mfma_f32_32x32x16_bf16 v[124:139], v[64:67], v[16:19], v[124:139]
    ds_read_b128 v[88:91], v9 offset:17408
    v_max3_f32 v4, v4, v100, v101
    v_max3_f32 v5, v5, v102, v103
    v_max3_f32 v4, v4, v104, v105
    v_max3_f32 v5, v5, v106, v107
    s_waitcnt lgkmcnt(4)
    v_mfma_f32_32x32x16_bf16 v[92:107], v[68:71], v[12:15], 0
    v_max3_f32 v4, v4, v108, v109
    v_max3_f32 v5, v5, v110, v111
    v_max3_f32 v4, v4, v112, v113
    v_max3_f32 v5, v5, v114, v115
    v_mfma_f32_32x32x16_bf16 v[92:107], v[72:75], v[16:19], v[92:107]
    v_max3_f32 v4, v4, v116, v117
    v_max3_f32 v5, v5, v118, v119
    v_max3_f32 v4, v4, v120, v121
    v_max3_f32 v5, v5, v122, v123
    s_waitcnt lgkmcnt(2)
    v_mfma_f32_32x32x16_bf16 v[108:123], v[76:79], v[12:15], 0
    v_max3_f32 v4, v4, v124, v125
    v_max3_f32 v5, v5, v126, v127
    v_max3_f32 v4, v4, v128, v129
    v_max3_f32 v5, v5, v130, v131
    v_mfma_f32_32x32x16_bf16 v[108:123], v[80:83], v[16:19], v[108:123]
    v_max3_f32 v4, v4, v132, v133
    v_max3_f32 v5, v5, v134, v135
    v_max3_f32 v4, v4, v136, v137
    v_max3_f32 v5, v5, v138, v139
    s_waitcnt lgkmcnt(0)
    v_mfma_f32_32x32x16_bf16 v[124:139], v[84:87], v[12:15], v[188:203]
    v_max3_f32 v4, v4, v92, v93
    v_max3_f32 v5, v5, v94, v95
    v_max3_f32 v4, v4, v96, v97
    v_max3_f32 v5, v5, v98, v99
    v_mfma_f32_32x32x16_bf16 v[124:139], v[88:91], v[16:19], v[124:139]
    v_max3_f32 v4, v4, v100, v101
    v_max3_f32 v5, v5, v102, v103
    v_max3_f32 v4, v4, v104, v105
    v_max3_f32 v5, v5, v106, v107
    s_barrier
    ds_read_b64_tr_b16 v[220:221], v6 offset:0
    ds_read_b64_tr_b16 v[222:223], v7 offset:0
    ds_read_b64_tr_b16 v[224:225], v6 offset:256
    ds_read_b64_tr_b16 v[226:227], v7 offset:256
    ds_read_b64_tr_b16 v[228:229], v6 offset:2048
    ds_read_b64_tr_b16 v[230:231], v7 offset:2048
    ds_read_b64_tr_b16 v[232:233], v6 offset:2304
    ds_read_b64_tr_b16 v[234:235], v7 offset:2304
    ds_read_b64_tr_b16 v[236:237], v6 offset:4096
    ds_read_b64_tr_b16 v[238:239], v7 offset:4096
    ds_read_b64_tr_b16 v[240:241], v6 offset:4352
    ds_read_b64_tr_b16 v[242:243], v7 offset:4352
    v_max3_f32 v4, v4, v108, v109
    v_max3_f32 v5, v5, v110, v111
    v_max3_f32 v4, v4, v112, v113
    v_max3_f32 v5, v5, v114, v115
    v_max3_f32 v4, v4, v116, v117
    v_max3_f32 v5, v5, v118, v119
    v_max3_f32 v4, v4, v120, v121
    v_max3_f32 v5, v5, v122, v123
    v_max3_f32 v4, v4, v124, v125
    v_max3_f32 v5, v5, v126, v127
    v_max3_f32 v4, v4, v128, v129
    v_max3_f32 v5, v5, v130, v131
    v_max3_f32 v4, v4, v132, v133
    v_max3_f32 v5, v5, v134, v135
    v_max3_f32 v4, v4, v136, v137
    v_max3_f32 v5, v5, v138, v139
    v_max_f32 v4, v4, v5
    v_mov_b32 v5, v4
    s_nop 1
    v_permlane32_swap_b32 v4, v5
    v_max_f32 v4, v4, v5
    v_pk_add_f32 v[172:173], v[172:173], v[4:5] op_sel_hi:[1,0] neg_lo:[0,1] neg_hi:[0,1]
    v_pk_add_f32 v[174:175], v[174:175], v[4:5] op_sel_hi:[1,0] neg_lo:[0,1] neg_hi:[0,1]
    v_pk_add_f32 v[176:177], v[176:177], v[4:5] op_sel_hi:[1,0] neg_lo:[0,1] neg_hi:[0,1]
    v_pk_add_f32 v[178:179], v[178:179], v[4:5] op_sel_hi:[1,0] neg_lo:[0,1] neg_hi:[0,1]
    v_pk_add_f32 v[180:181], v[180:181], v[4:5] op_sel_hi:[1,0] neg_lo:[0,1] neg_hi:[0,1]
    v_pk_add_f32 v[182:183], v[182:183], v[4:5] op_sel_hi:[1,0] neg_lo:[0,1] neg_hi:[0,1]
    v_pk_add_f32 v[184:185], v[184:185], v[4:5] op_sel_hi:[1,0] neg_lo:[0,1] neg_hi:[0,1]
    v_pk_add_f32 v[186:187], v[186:187], v[4:5] op_sel_hi:[1,0] neg_lo:[0,1] neg_hi:[0,1]
    s_nop 1
    v_mfma_f32_32x32x16_bf16 v[92:107], v[20:23], v[12:15], v[172:187]
    v_mfma_f32_32x32x16_bf16 v[92:107], v[24:27], v[16:19], v[92:107]
    v_pk_add_f32 v[204:205], v[4:5], 0 op_sel_hi:[0,0] neg_lo:[1,0] neg_hi:[1,0]
    v_pk_add_f32 v[206:207], v[4:5], 0 op_sel_hi:[0,0] neg_lo:[1,0] neg_hi:[1,0]
    v_pk_add_f32 v[208:209], v[4:5], 0 op_sel_hi:[0,0] neg_lo:[1,0] neg_hi:[1,0]
    v_pk_add_f32 v[210:211], v[4:5], 0 op_sel_hi:[0,0] neg_lo:[1,0] neg_hi:[1,0]
    v_pk_add_f32 v[212:213], v[4:5], 0 op_sel_hi:[0,0] neg_lo:[1,0] neg_hi:[1,0]
    v_pk_add_f32 v[214:215], v[4:5], 0 op_sel_hi:[0,0] neg_lo:[1,0] neg_hi:[1,0]
    v_pk_add_f32 v[216:217], v[4:5], 0 op_sel_hi:[0,0] neg_lo:[1,0] neg_hi:[1,0]
    v_pk_add_f32 v[218:219], v[4:5], 0 op_sel_hi:[0,0] neg_lo:[1,0] neg_hi:[1,0]
    s_nop 1
    v_mfma_f32_32x32x16_bf16 v[108:123], v[28:31], v[12:15], v[204:219]
    v_mfma_f32_32x32x16_bf16 v[108:123], v[32:35], v[16:19], v[108:123]
    v_exp_f32 v92, v92
    v_exp_f32 v93, v93
    v_mfma_f32_32x32x16_bf16 v[124:139], v[36:39], v[12:15], v[204:219]
    v_exp_f32 v94, v94
    v_exp_f32 v95, v95
    v_exp_f32 v96, v96
    v_exp_f32 v97, v97
    v_mfma_f32_32x32x16_bf16 v[124:139], v[40:43], v[16:19], v[124:139]
    v_exp_f32 v98, v98
    v_exp_f32 v99, v99
    v_exp_f32 v100, v100
    v_exp_f32 v101, v101
    v_exp_f32 v102, v102
    v_exp_f32 v103, v103
    v_exp_f32 v104, v104
    v_exp_f32 v105, v105
    v_exp_f32 v106, v106
    v_exp_f32 v107, v107
    v_cvt_pk_bf16_f32 v140, v92, v93
    v_cvt_pk_bf16_f32 v141, v94, v95
    v_cvt_pk_bf16_f32 v142, v96, v97
    v_cvt_pk_bf16_f32 v143, v98, v99
    v_cvt_pk_bf16_f32 v144, v100, v101
    v_cvt_pk_bf16_f32 v145, v102, v103
    v_cvt_pk_bf16_f32 v146, v104, v105
    v_cvt_pk_bf16_f32 v147, v106, v107
    v_sub_f32 v188, v188, v4
    v_sub_f32 v189, v189, v4
    v_sub_f32 v190, v190, v4
    v_sub_f32 v191, v191, v4
    s_waitcnt lgkmcnt(8)
    v_exp_f32 v108, v108
    v_exp_f32 v109, v109
    v_mfma_f32_32x32x16_bf16 v[156:171], v[220:223], v[140:143], 0
    v_exp_f32 v110, v110
    v_exp_f32 v111, v111
    v_exp_f32 v112, v112
    v_exp_f32 v113, v113
    v_mfma_f32_32x32x16_bf16 v[156:171], v[224:227], v[144:147], v[156:171]
    v_exp_f32 v114, v114
    v_exp_f32 v115, v115
    v_exp_f32 v116, v116
    v_exp_f32 v117, v117
    v_mfma_f32_32x32x16_bf16 v[92:107], v[44:47], v[12:15], v[204:219]
    v_exp_f32 v118, v118
    ds_read_b64_tr_b16 v[244:245], v6 offset:6144
    ds_read_b64_tr_b16 v[246:247], v7 offset:6144
    ds_read_b64_tr_b16 v[248:249], v6 offset:6400
    ds_read_b64_tr_b16 v[250:251], v7 offset:6400
    v_exp_f32 v119, v119
    v_exp_f32 v120, v120
    v_exp_f32 v121, v121
    v_mfma_f32_32x32x16_bf16 v[92:107], v[48:51], v[16:19], v[92:107]
    v_exp_f32 v122, v122
    v_exp_f32 v123, v123
    v_cvt_pk_bf16_f32 v148, v108, v109
    v_cvt_pk_bf16_f32 v149, v110, v111
    v_cvt_pk_bf16_f32 v150, v112, v113
    v_cvt_pk_bf16_f32 v151, v114, v115
    v_cvt_pk_bf16_f32 v152, v116, v117
    v_cvt_pk_bf16_f32 v153, v118, v119
    v_cvt_pk_bf16_f32 v154, v120, v121
    v_cvt_pk_bf16_f32 v155, v122, v123
    v_sub_f32 v192, v192, v4
    v_sub_f32 v193, v193, v4
    v_sub_f32 v194, v194, v4
    v_sub_f32 v195, v195, v4
    s_waitcnt lgkmcnt(8)
    v_exp_f32 v124, v124
    v_exp_f32 v125, v125
    v_mfma_f32_32x32x16_bf16 v[156:171], v[228:231], v[148:151], v[156:171]
    v_exp_f32 v126, v126
    v_exp_f32 v127, v127
    v_exp_f32 v128, v128
    v_exp_f32 v129, v129
    v_mfma_f32_32x32x16_bf16 v[156:171], v[232:235], v[152:155], v[156:171]
    v_exp_f32 v130, v130
    v_exp_f32 v131, v131
    v_exp_f32 v132, v132
    v_exp_f32 v133, v133
    v_mfma_f32_32x32x16_bf16 v[108:123], v[52:55], v[12:15], v[204:219]
    v_exp_f32 v134, v134
    ds_read_b64_tr_b16 v[220:221], v6 offset:8192
    ds_read_b64_tr_b16 v[222:223], v7 offset:8192
    ds_read_b64_tr_b16 v[224:225], v6 offset:8448
    ds_read_b64_tr_b16 v[226:227], v7 offset:8448
    v_exp_f32 v135, v135
    v_exp_f32 v136, v136
    v_exp_f32 v137, v137
    v_mfma_f32_32x32x16_bf16 v[108:123], v[56:59], v[16:19], v[108:123]
    v_exp_f32 v138, v138
    v_exp_f32 v139, v139
    v_cvt_pk_bf16_f32 v140, v124, v125
    v_cvt_pk_bf16_f32 v141, v126, v127
    v_cvt_pk_bf16_f32 v142, v128, v129
    v_cvt_pk_bf16_f32 v143, v130, v131
    v_cvt_pk_bf16_f32 v144, v132, v133
    v_cvt_pk_bf16_f32 v145, v134, v135
    v_cvt_pk_bf16_f32 v146, v136, v137
    v_cvt_pk_bf16_f32 v147, v138, v139
    v_sub_f32 v196, v196, v4
    v_sub_f32 v197, v197, v4
    v_sub_f32 v198, v198, v4
    v_sub_f32 v199, v199, v4
    s_waitcnt lgkmcnt(8)
    v_exp_f32 v92, v92
    v_exp_f32 v93, v93
    v_mfma_f32_32x32x16_bf16 v[156:171], v[236:239], v[140:143], v[156:171]
    v_exp_f32 v94, v94
    v_exp_f32 v95, v95
    v_exp_f32 v96, v96
    v_exp_f32 v97, v97
    v_mfma_f32_32x32x16_bf16 v[156:171], v[240:243], v[144:147], v[156:171]
    v_exp_f32 v98, v98
    v_exp_f32 v99, v99
    v_exp_f32 v100, v100
    v_exp_f32 v101, v101
    v_mfma_f32_32x32x16_bf16 v[124:139], v[60:63], v[12:15], v[204:219]
    v_exp_f32 v102, v102
    ds_read_b64_tr_b16 v[228:229], v6 offset:10240
    ds_read_b64_tr_b16 v[230:231], v7 offset:10240
    ds_read_b64_tr_b16 v[232:233], v6 offset:10496
    ds_read_b64_tr_b16 v[234:235], v7 offset:10496
    v_exp_f32 v103, v103
    v_exp_f32 v104, v104
    v_exp_f32 v105, v105
    v_mfma_f32_32x32x16_bf16 v[124:139], v[64:67], v[16:19], v[124:139]
    v_exp_f32 v106, v106
    v_exp_f32 v107, v107
    v_cvt_pk_bf16_f32 v148, v92, v93
    v_cvt_pk_bf16_f32 v149, v94, v95
    v_cvt_pk_bf16_f32 v150, v96, v97
    v_cvt_pk_bf16_f32 v151, v98, v99
    v_cvt_pk_bf16_f32 v152, v100, v101
    v_cvt_pk_bf16_f32 v153, v102, v103
    v_cvt_pk_bf16_f32 v154, v104, v105
    v_cvt_pk_bf16_f32 v155, v106, v107
    v_sub_f32 v200, v200, v4
    v_sub_f32 v201, v201, v4
    v_sub_f32 v202, v202, v4
    v_sub_f32 v203, v203, v4
    s_waitcnt lgkmcnt(8)
    v_exp_f32 v108, v108
    v_exp_f32 v109, v109
    v_mfma_f32_32x32x16_bf16 v[156:171], v[244:247], v[148:151], v[156:171]
    v_exp_f32 v110, v110
    v_exp_f32 v111, v111
    v_exp_f32 v112, v112
    v_exp_f32 v113, v113
    v_mfma_f32_32x32x16_bf16 v[156:171], v[248:251], v[152:155], v[156:171]
    v_exp_f32 v114, v114
    v_exp_f32 v115, v115
    v_exp_f32 v116, v116
    v_exp_f32 v117, v117
    v_mfma_f32_32x32x16_bf16 v[92:107], v[68:71], v[12:15], v[204:219]
    v_exp_f32 v118, v118
    ds_read_b64_tr_b16 v[236:237], v6 offset:12288
    ds_read_b64_tr_b16 v[238:239], v7 offset:12288
    ds_read_b64_tr_b16 v[240:241], v6 offset:12544
    ds_read_b64_tr_b16 v[242:243], v7 offset:12544
    v_exp_f32 v119, v119
    v_exp_f32 v120, v120
    v_exp_f32 v121, v121
    v_mfma_f32_32x32x16_bf16 v[92:107], v[72:75], v[16:19], v[92:107]
    v_exp_f32 v122, v122
    v_exp_f32 v123, v123
    v_cvt_pk_bf16_f32 v140, v108, v109
    v_cvt_pk_bf16_f32 v141, v110, v111
    v_cvt_pk_bf16_f32 v142, v112, v113
    v_cvt_pk_bf16_f32 v143, v114, v115
    v_cvt_pk_bf16_f32 v144, v116, v117
    v_cvt_pk_bf16_f32 v145, v118, v119
    v_cvt_pk_bf16_f32 v146, v120, v121
    v_cvt_pk_bf16_f32 v147, v122, v123
    s_waitcnt lgkmcnt(8)
    v_exp_f32 v124, v124
    v_exp_f32 v125, v125
    v_mfma_f32_32x32x16_bf16 v[156:171], v[220:223], v[140:143], v[156:171]
    v_exp_f32 v126, v126
    v_exp_f32 v127, v127
    v_exp_f32 v128, v128
    v_exp_f32 v129, v129
    v_mfma_f32_32x32x16_bf16 v[156:171], v[224:227], v[144:147], v[156:171]
    v_exp_f32 v130, v130
    v_exp_f32 v131, v131
    v_exp_f32 v132, v132
    v_exp_f32 v133, v133
    v_mfma_f32_32x32x16_bf16 v[108:123], v[76:79], v[12:15], v[204:219]
    v_exp_f32 v134, v134
    ds_read_b64_tr_b16 v[244:245], v6 offset:14336
    ds_read_b64_tr_b16 v[246:247], v7 offset:14336
    ds_read_b64_tr_b16 v[248:249], v6 offset:14592
    ds_read_b64_tr_b16 v[250:251], v7 offset:14592
    v_exp_f32 v135, v135
    v_exp_f32 v136, v136
    v_exp_f32 v137, v137
    v_mfma_f32_32x32x16_bf16 v[108:123], v[80:83], v[16:19], v[108:123]
    v_exp_f32 v138, v138
    v_exp_f32 v139, v139
    v_cvt_pk_bf16_f32 v148, v124, v125
    v_cvt_pk_bf16_f32 v149, v126, v127
    v_cvt_pk_bf16_f32 v150, v128, v129
    v_cvt_pk_bf16_f32 v151, v130, v131
    v_cvt_pk_bf16_f32 v152, v132, v133
    v_cvt_pk_bf16_f32 v153, v134, v135
    v_cvt_pk_bf16_f32 v154, v136, v137
    v_cvt_pk_bf16_f32 v155, v138, v139
    s_waitcnt lgkmcnt(8)
    v_exp_f32 v92, v92
    v_exp_f32 v93, v93
    v_mfma_f32_32x32x16_bf16 v[156:171], v[228:231], v[148:151], v[156:171]
    v_exp_f32 v94, v94
    v_exp_f32 v95, v95
    v_exp_f32 v96, v96
    v_exp_f32 v97, v97
    v_mfma_f32_32x32x16_bf16 v[156:171], v[232:235], v[152:155], v[156:171]
    v_exp_f32 v98, v98
    v_exp_f32 v99, v99
    v_exp_f32 v100, v100
    v_exp_f32 v101, v101
    v_mfma_f32_32x32x16_bf16 v[124:139], v[84:87], v[12:15], v[188:203]
    v_exp_f32 v102, v102
    ds_read_b64_tr_b16 v[220:221], v6 offset:16384
    ds_read_b64_tr_b16 v[222:223], v7 offset:16384
    ds_read_b64_tr_b16 v[224:225], v6 offset:16640
    ds_read_b64_tr_b16 v[226:227], v7 offset:16640
    v_exp_f32 v103, v103
    v_exp_f32 v104, v104
    v_exp_f32 v105, v105
    v_mfma_f32_32x32x16_bf16 v[124:139], v[88:91], v[16:19], v[124:139]
    v_exp_f32 v106, v106
    v_exp_f32 v107, v107
    v_cvt_pk_bf16_f32 v140, v92, v93
    v_cvt_pk_bf16_f32 v141, v94, v95
    v_cvt_pk_bf16_f32 v142, v96, v97
    v_cvt_pk_bf16_f32 v143, v98, v99
    v_cvt_pk_bf16_f32 v144, v100, v101
    v_cvt_pk_bf16_f32 v145, v102, v103
    v_cvt_pk_bf16_f32 v146, v104, v105
    v_cvt_pk_bf16_f32 v147, v106, v107
    s_waitcnt lgkmcnt(8)
    v_exp_f32 v108, v108
    v_exp_f32 v109, v109
    v_mfma_f32_32x32x16_bf16 v[156:171], v[236:239], v[140:143], v[156:171]
    v_exp_f32 v110, v110
    v_exp_f32 v111, v111
    v_exp_f32 v112, v112
    v_exp_f32 v113, v113
    v_mfma_f32_32x32x16_bf16 v[156:171], v[240:243], v[144:147], v[156:171]
    v_exp_f32 v114, v114
    v_exp_f32 v115, v115
    v_exp_f32 v116, v116
    v_exp_f32 v117, v117
    v_exp_f32 v118, v118
    v_exp_f32 v119, v119
    v_exp_f32 v120, v120
    v_exp_f32 v121, v121
    v_exp_f32 v122, v122
    v_exp_f32 v123, v123
    v_cvt_pk_bf16_f32 v148, v108, v109
    v_cvt_pk_bf16_f32 v149, v110, v111
    v_cvt_pk_bf16_f32 v150, v112, v113
    v_cvt_pk_bf16_f32 v151, v114, v115
    v_cvt_pk_bf16_f32 v152, v116, v117
    v_cvt_pk_bf16_f32 v153, v118, v119
    v_cvt_pk_bf16_f32 v154, v120, v121
    v_cvt_pk_bf16_f32 v155, v122, v123
    s_waitcnt lgkmcnt(4)
    v_exp_f32 v124, v124
    v_exp_f32 v125, v125
    v_mfma_f32_32x32x16_bf16 v[156:171], v[244:247], v[148:151], v[156:171]
    v_exp_f32 v126, v126
    v_exp_f32 v127, v127
    v_exp_f32 v128, v128
    v_exp_f32 v129, v129
    v_mfma_f32_32x32x16_bf16 v[156:171], v[248:251], v[152:155], v[156:171]
    v_exp_f32 v130, v130
    v_exp_f32 v131, v131
    v_exp_f32 v132, v132
    v_exp_f32 v133, v133
    v_exp_f32 v134, v134
    v_exp_f32 v135, v135
    v_exp_f32 v136, v136
    v_exp_f32 v137, v137
    v_exp_f32 v138, v138
    v_exp_f32 v139, v139
    v_cvt_pk_bf16_f32 v140, v124, v125
    v_cvt_pk_bf16_f32 v141, v126, v127
    v_cvt_pk_bf16_f32 v142, v128, v129
    v_cvt_pk_bf16_f32 v143, v130, v131
    v_cvt_pk_bf16_f32 v144, v132, v133
    v_cvt_pk_bf16_f32 v145, v134, v135
    v_cvt_pk_bf16_f32 v146, v136, v137
    v_cvt_pk_bf16_f32 v147, v138, v139
    s_waitcnt lgkmcnt(0)
    v_mfma_f32_32x32x16_bf16 v[156:171], v[220:223], v[140:143], v[156:171]
    v_mfma_f32_32x32x16_bf16 v[156:171], v[224:227], v[144:147], v[156:171]
    s_nop 11
    v_mov_b32 v4, v168
    v_mov_b32 v5, v168
    s_nop 1
    v_permlane32_swap_b32 v4, v5
    v_rcp_f32 v4, v5
    s_nop 0
    v_pk_mul_f32 v[156:157], v[156:157], v[4:5] op_sel_hi:[1,0]
    v_pk_mul_f32 v[158:159], v[158:159], v[4:5] op_sel_hi:[1,0]
    v_pk_mul_f32 v[160:161], v[160:161], v[4:5] op_sel_hi:[1,0]
    v_pk_mul_f32 v[162:163], v[162:163], v[4:5] op_sel_hi:[1,0]
    v_cvt_pk_bf16_f32 v20, v156, v157
    v_cvt_pk_bf16_f32 v21, v158, v159
    v_cvt_pk_bf16_f32 v22, v160, v161
    v_cvt_pk_bf16_f32 v23, v162, v163
    buffer_store_dwordx4 v[20:23], v8, s[72:75], s42 offen offset:0 sc1
    v_pk_mul_f32 v[164:165], v[164:165], v[4:5] op_sel_hi:[1,0]
    v_pk_mul_f32 v[166:167], v[166:167], v[4:5] op_sel_hi:[1,0]
    v_pk_mul_f32 v[168:169], v[168:169], v[4:5] op_sel_hi:[1,0]
    v_pk_mul_f32 v[170:171], v[170:171], v[4:5] op_sel_hi:[1,0]
    v_cvt_pk_bf16_f32 v24, v164, v165
    v_cvt_pk_bf16_f32 v25, v166, v167
    v_cvt_pk_bf16_f32 v26, v168, v169
    v_cvt_pk_bf16_f32 v27, v170, v171
    v_cndmask_b32 v26, v26, 0, s[30:31]
    v_cndmask_b32 v27, v27, 0, s[30:31]
    buffer_store_dwordx4 v[24:27], v8, s[72:75], s42 offen offset:1024 sc1
    s_and_b32 s39, s58, 3
    s_lshl_b32 s37, s57, 2
    s_add_u32 s37, s37, s39
    s_lshr_b32 s38, s58, 2
    s_lshl_b32 s42, s38, 7
    s_and_b32 s44, s36, 1
    s_lshr_b32 s45, s36, 1
    v_and_b32 v3, 31, v1
    v_lshrrev_b32 v4, 5, v1
    v_lshlrev_b32 v10, 6, v3
    v_lshl_add_u32 v10, v4, 3, v10
    s_lshl_b32 s47, s36, 11
    s_add_u32 s47, s47, 114688
    v_add_u32 v10, s47, v10
    s_lshl_b32 s46, s37, 6
    s_lshl_b32 s47, s44, 5
    s_add_u32 s46, s46, s47
    s_lshl_b32 s52, s37, 1
    s_add_u32 s52, s52, s44
    s_mul_i32 s52, s52, 28
    s_lshl_b32 s53, s38, 2
    s_add_u32 s52, s52, s53
    s_lshl_b32 s53, s45, 1
    s_add_u32 s52, s52, s53
    s_lshl_b32 s52, s52, 10
    s_add_u32 s52, s52, 2097152
    v_lshlrev_b32 v13, 4, v1
    v_add_u32 v9, s46, v3
    v_lshlrev_b32 v9, 3, v9
    s_lshl_b32 s54, s38, 1
    s_add_u32 s54, s54, s45
    s_mul_i32 s54, s54, 16384
    s_add_u32 s54, s54, 12582912
    s_mov_b32 s55, 1065369472
    s_lshl_b32 s47, s44, 12
    v_add_u32 v104, s47, v13
    s_mov_b32 s50, 0xffff0000
    v_lshrrev_b32 v4, 5, v1
    v_bfe_u32 v3, v1, 2, 2
    v_lshl_add_u32 v5, v4, 2, v3
    v_lshlrev_b32 v5, 7, v5
    v_bfe_u32 v6, v1, 4, 1
    v_lshlrev_b32 v6, 1, v6
    v_bfe_u32 v7, v1, 1, 1
    v_add_u32 v6, v6, v7
    s_lshl_b32 s47, s45, 2
    v_add_u32 v6, s47, v6
    v_lshrrev_b32 v7, 1, v3
    v_lshlrev_b32 v7, 2, v7
    v_xor_b32 v6, v6, v7
    v_lshl_add_u32 v5, v6, 4, v5
    v_and_b32 v7, 1, v1
    v_lshl_add_u32 v105, v7, 3, v5
    v_add_u32 v105, 49152, v105
    v_mov_b32 v44, 163836
    v_mov_b32 v45, 1
    s_mov_b64 exec, 1
    s_waitcnt vmcnt(0)
    ds_add_rtn_u32 v45, v44, v45
    s_waitcnt lgkmcnt(0)
    v_readfirstlane_b32 s62, v45
    s_nop 0
    s_and_b32 s62, s62, 3
    s_cmp_lg_u32 s62, 3
    s_cbranch_scc1 mk_10
    v_mov_b32 v44, 0
    v_mov_b32 v45, s63
    buffer_store_dword v45, v44, s[72:75], s61 offen sc1
mk_10:
    s_mov_b64 exec, -1
    s_barrier
    s_cmp_ge_u32 s2, 224
    s_cbranch_scc1 mk_colsum
    ds_read_b64 v[96:97], v10 offset:0
    ds_read_b64 v[98:99], v10 offset:16
    ds_read_b64 v[100:101], v10 offset:32
    ds_read_b64 v[102:103], v10 offset:48
    ds_read_b64_tr_b16 v[128:129], v105 offset:0
    ds_read_b64_tr_b16 v[130:131], v105 offset:1024
    ds_read_b64_tr_b16 v[132:133], v105 offset:2048
    ds_read_b64_tr_b16 v[134:135], v105 offset:3072
    ds_read_b64_tr_b16 v[136:137], v105 offset:4096
    ds_read_b64_tr_b16 v[138:139], v105 offset:5120
    ds_read_b64_tr_b16 v[140:141], v105 offset:6144
    ds_read_b64_tr_b16 v[142:143], v105 offset:7168
    ds_read_b64_tr_b16 v[144:145], v105 offset:8192
    ds_read_b64_tr_b16 v[146:147], v105 offset:9216
    ds_read_b64_tr_b16 v[148:149], v105 offset:10240
    ds_read_b64_tr_b16 v[150:151], v105 offset:11264
    ds_read_b64_tr_b16 v[152:153], v105 offset:12288
    ds_read_b64_tr_b16 v[154:155], v105 offset:13312
    ds_read_b64_tr_b16 v[156:157], v105 offset:14336
    ds_read_b64_tr_b16 v[158:159], v105 offset:15360
    ds_read_b64_tr_b16 v[160:161], v105 offset:16384
    ds_read_b64_tr_b16 v[162:163], v105 offset:17408
    ds_read_b64_tr_b16 v[164:165], v105 offset:18432
    ds_read_b64_tr_b16 v[166:167], v105 offset:19456
    ds_read_b64_tr_b16 v[168:169], v105 offset:20480
    ds_read_b64_tr_b16 v[170:171], v105 offset:21504
    ds_read_b64_tr_b16 v[172:173], v105 offset:22528
    ds_read_b64_tr_b16 v[174:175], v105 offset:23552
    ds_read_b64_tr_b16 v[176:177], v105 offset:24576
    ds_read_b64_tr_b16 v[178:179], v105 offset:25600
    ds_read_b64_tr_b16 v[180:181], v105 offset:26624
    ds_read_b64_tr_b16 v[182:183], v105 offset:27648
    ds_read_b64_tr_b16 v[184:185], v105 offset:28672
    ds_read_b64_tr_b16 v[186:187], v105 offset:29696
    ds_read_b64_tr_b16 v[188:189], v105 offset:30720
    ds_read_b64_tr_b16 v[190:191], v105 offset:31744
    ds_read_b64_tr_b16 v[192:193], v105 offset:32768
    ds_read_b64_tr_b16 v[194:195], v105 offset:33792
    ds_read_b64_tr_b16 v[196:197], v105 offset:34816
    ds_read_b64_tr_b16 v[198:199], v105 offset:35840
    ds_read_b64_tr_b16 v[200:201], v105 offset:36864
    ds_read_b64_tr_b16 v[202:203], v105 offset:37888
    ds_read_b64_tr_b16 v[204:205], v105 offset:38912
    ds_read_b64_tr_b16 v[206:207], v105 offset:39936
    ds_read_b64_tr_b16 v[208:209], v105 offset:40960
    ds_read_b64_tr_b16 v[210:211], v105 offset:41984
    ds_read_b64_tr_b16 v[212:213], v105 offset:43008
    ds_read_b64_tr_b16 v[214:215], v105 offset:44032
    ds_read_b64_tr_b16 v[216:217], v105 offset:45056
    ds_read_b64_tr_b16 v[218:219], v105 offset:46080
    ds_read_b64_tr_b16 v[220:221], v105 offset:47104
    ds_read_b64_tr_b16 v[222:223], v105 offset:48128
    ds_read_b64_tr_b16 v[224:225], v105 offset:49152
    ds_read_b64_tr_b16 v[226:227], v105 offset:50176
    ds_read_b64_tr_b16 v[228:229], v105 offset:51200
    ds_read_b64_tr_b16 v[230:231], v105 offset:52224
    ds_read_b64_tr_b16 v[232:233], v105 offset:53248
    ds_read_b64_tr_b16 v[234:235], v105 offset:54272
    ds_read_b64_tr_b16 v[236:237], v105 offset:55296
    ds_read_b64_tr_b16 v[238:239], v105 offset:56320
    ds_read_b64_tr_b16 v[240:241], v105 offset:57344
    ds_read_b64_tr_b16 v[242:243], v105 offset:58368
    ds_read_b64_tr_b16 v[244:245], v105 offset:59392
    ds_read_b64_tr_b16 v[246:247], v105 offset:60416
    ds_read_b64_tr_b16 v[248:249], v105 offset:61440
    ds_read_b64_tr_b16 v[250:251], v105 offset:62464
    ds_read_b64_tr_b16 v[252:253], v105 offset:63488
    ds_read_b64_tr_b16 v[254:255], v105 offset:64512
    s_lshr_b32 s61, s37, 1
    s_lshl_b32 s61, s61, 4
    s_and_b32 s53, s37, 1
    s_mul_i32 s53, s53, 7
    s_add_u32 s61, s61, s53
    s_add_u32 s61, s61, s38
    s_lshl_b32 s61, s61, 8
    s_add_u32 s61, s61, 37945344
    s_waitcnt lgkmcnt(0)
    s_barrier
    v_lshlrev_b32 v16, 16, v96
    v_and_b32 v17, s50, v96
    v_lshlrev_b32 v18, 16, v97
    v_and_b32 v19, s50, v97
    v_lshlrev_b32 v20, 16, v98
    v_and_b32 v21, s50, v98
    v_lshlrev_b32 v22, 16, v99
    v_and_b32 v23, s50, v99
    v_lshlrev_b32 v24, 16, v100
    v_and_b32 v25, s50, v100
    v_lshlrev_b32 v26, 16, v101
    v_and_b32 v27, s50, v101
    v_lshlrev_b32 v28, 16, v102
    v_and_b32 v29, s50, v102
    v_lshlrev_b32 v30, 16, v103
    v_and_b32 v31, s50, v103
    s_barrier
    s_barrier
    ds_read_b128 v[32:35], v104 offset:0
    ds_read_b128 v[36:39], v104 offset:1024
    ds_read_b128 v[40:43], v104 offset:2048
    ds_read_b128 v[44:47], v104 offset:3072
    ds_read_b128 v[48:51], v104 offset:8192
    ds_read_b128 v[52:55], v104 offset:9216
    ds_read_b128 v[56:59], v104 offset:10240
    ds_read_b128 v[60:63], v104 offset:11264
    s_waitcnt lgkmcnt(7)
    v_mfma_f32_32x32x16_bf16 v[16:31], v[128:131], v[32:35], v[16:31]
    s_waitcnt lgkmcnt(6)
    v_mfma_f32_32x32x16_bf16 v[16:31], v[132:135], v[36:39], v[16:31]
    s_waitcnt lgkmcnt(5)
    v_mfma_f32_32x32x16_bf16 v[16:31], v[136:139], v[40:43], v[16:31]
    s_waitcnt lgkmcnt(4)
    v_mfma_f32_32x32x16_bf16 v[16:31], v[140:143], v[44:47], v[16:31]
    s_waitcnt lgkmcnt(3)
    v_mfma_f32_32x32x16_bf16 v[16:31], v[144:147], v[48:51], v[16:31]
    s_waitcnt lgkmcnt(0)
    s_barrier
    ds_read_b128 v[64:67], v104 offset:16384
    ds_read_b128 v[68:71], v104 offset:17408
    v_mfma_f32_32x32x16_bf16 v[16:31], v[148:151], v[52:55], v[16:31]
    ds_read_b128 v[72:75], v104 offset:18432
    ds_read_b128 v[76:79], v104 offset:19456
    v_mfma_f32_32x32x16_bf16 v[16:31], v[152:155], v[56:59], v[16:31]
    ds_read_b128 v[80:83], v104 offset:24576
    ds_read_b128 v[84:87], v104 offset:25600
    v_mfma_f32_32x32x16_bf16 v[16:31], v[156:159], v[60:63], v[16:31]
    ds_read_b128 v[88:91], v104 offset:26624
    ds_read_b128 v[92:95], v104 offset:27648
    s_waitcnt lgkmcnt(7)
    v_mfma_f32_32x32x16_bf16 v[16:31], v[160:163], v[64:67], v[16:31]
    s_waitcnt lgkmcnt(6)
    v_mfma_f32_32x32x16_bf16 v[16:31], v[164:167], v[68:71], v[16:31]
    s_waitcnt lgkmcnt(5)
    v_mfma_f32_32x32x16_bf16 v[16:31], v[168:171], v[72:75], v[16:31]
    s_waitcnt lgkmcnt(4)
    v_mfma_f32_32x32x16_bf16 v[16:31], v[172:175], v[76:79], v[16:31]
    s_waitcnt lgkmcnt(3)
    v_mfma_f32_32x32x16_bf16 v[16:31], v[176:179], v[80:83], v[16:31]
    s_waitcnt lgkmcnt(0)
    s_barrier
    ds_read_b128 v[32:35], v104 offset:32768
    ds_read_b128 v[36:39], v104 offset:33792
    v_mfma_f32_32x32x16_bf16 v[16:31], v[180:183], v[84:87], v[16:31]
    ds_read_b128 v[40:43], v104 offset:34816
    ds_read_b128 v[44:47], v104 offset:35840
    v_mfma_f32_32x32x16_bf16 v[16:31], v[184:187], v[88:91], v[16:31]
    ds_read_b128 v[48:51], v104 offset:40960
    ds_read_b128 v[52:55], v104 offset:41984
    v_mfma_f32_32x32x16_bf16 v[16:31], v[188:191], v[92:95], v[16:31]
    ds_read_b128 v[56:59], v104 offset:43008
    ds_read_b128 v[60:63], v104 offset:44032
    s_waitcnt lgkmcnt(7)
    v_mfma_f32_32x32x16_bf16 v[16:31], v[192:195], v[32:35], v[16:31]
    s_waitcnt lgkmcnt(6)
    v_mfma_f32_32x32x16_bf16 v[16:31], v[196:199], v[36:39], v[16:31]
    s_waitcnt lgkmcnt(5)
    v_mfma_f32_32x32x16_bf16 v[16:31], v[200:203], v[40:43], v[16:31]
    s_waitcnt lgkmcnt(4)
    v_mfma_f32_32x32x16_bf16 v[16:31], v[204:207], v[44:47], v[16:31]
    s_waitcnt lgkmcnt(3)
    v_mfma_f32_32x32x16_bf16 v[16:31], v[208:211], v[48:51], v[16:31]
    s_waitcnt lgkmcnt(0)
    s_barrier
    ds_read_b128 v[64:67], v104 offset:49152
    ds_read_b128 v[68:71], v104 offset:50176
    v_mfma_f32_32x32x16_bf16 v[16:31], v[212:215], v[52:55], v[16:31]
    ds_read_b128 v[72:75], v104 offset:51200
    ds_read_b128 v[76:79], v104 offset:52224
    v_mfma_f32_32x32x16_bf16 v[16:31], v[216:219], v[56:59], v[16:31]
    ds_read_b128 v[80:83], v104 offset:57344
    ds_read_b128 v[84:87], v104 offset:58368
    v_mfma_f32_32x32x16_bf16 v[16:31], v[220:223], v[60:63], v[16:31]
    ds_read_b128 v[88:91], v104 offset:59392
    ds_read_b128 v[92:95], v104 offset:60416
    s_waitcnt lgkmcnt(7)
    v_mfma_f32_32x32x16_bf16 v[16:31], v[224:227], v[64:67], v[16:31]
    s_waitcnt lgkmcnt(6)
    v_mfma_f32_32x32x16_bf16 v[16:31], v[228:231], v[68:71], v[16:31]
    s_waitcnt lgkmcnt(5)
    v_mfma_f32_32x32x16_bf16 v[16:31], v[232:235], v[72:75], v[16:31]
    s_waitcnt lgkmcnt(4)
    v_mfma_f32_32x32x16_bf16 v[16:31], v[236:239], v[76:79], v[16:31]
    s_waitcnt lgkmcnt(3)
    v_mfma_f32_32x32x16_bf16 v[16:31], v[240:243], v[80:83], v[16:31]
    s_waitcnt lgkmcnt(2)
    v_mfma_f32_32x32x16_bf16 v[16:31], v[244:247], v[84:87], v[16:31]
    s_waitcnt lgkmcnt(1)
    v_mfma_f32_32x32x16_bf16 v[16:31], v[248:251], v[88:91], v[16:31]
    s_waitcnt lgkmcnt(0)
    v_mfma_f32_32x32x16_bf16 v[16:31], v[252:255], v[92:95], v[16:31]
    s_nop 11
    v_cvt_pk_bf16_f32 v108, v16, v17
    v_cvt_pk_bf16_f32 v109, v18, v19
    v_cvt_pk_bf16_f32 v110, v20, v21
    v_cvt_pk_bf16_f32 v111, v22, v23
    buffer_store_dwordx4 v[108:111], v13, s[72:75], s52 offen offset:0 sc1
    v_cvt_pk_bf16_f32 v112, v24, v25
    v_cvt_pk_bf16_f32 v113, v26, v27
    v_cvt_pk_bf16_f32 v114, v28, v29
    v_cvt_pk_bf16_f32 v115, v30, v31
    buffer_store_dwordx4 v[112:115], v13, s[72:75], s52 offen offset:1024 sc1
    v_dot2_f32_bf16 v40, v108, s55, 0
    v_dot2_f32_bf16 v41, v108, v108, 0
    v_dot2_f32_bf16 v40, v109, s55, v40
    v_dot2_f32_bf16 v41, v109, v109, v41
    v_dot2_f32_bf16 v40, v110, s55, v40
    v_dot2_f32_bf16 v41, v110, v110, v41
    v_dot2_f32_bf16 v40, v111, s55, v40
    v_dot2_f32_bf16 v41, v111, v111, v41
    v_dot2_f32_bf16 v40, v112, s55, v40
    v_dot2_f32_bf16 v41, v112, v112, v41
    v_dot2_f32_bf16 v40, v113, s55, v40
    v_dot2_f32_bf16 v41, v113, v113, v41
    v_dot2_f32_bf16 v40, v114, s55, v40
    v_dot2_f32_bf16 v41, v114, v114, v41
    v_dot2_f32_bf16 v40, v115, s55, v40
    v_dot2_f32_bf16 v41, v115, v115, v41
    s_nop 1
    v_mov_b32 v42, v40
    v_mov_b32 v43, v41
    s_nop 0
    v_permlane32_swap_b32 v40, v42
    v_permlane32_swap_b32 v41, v43
    v_add_f32 v40, v40, v42
    v_add_f32 v41, v41, v43
    s_mov_b32 exec_hi, 0
    buffer_store_dwordx2 v[40:41], v9, s[72:75], s54 offen sc1
    s_mov_b64 exec, -1
    v_mov_b32 v44, 163836
    v_mov_b32 v45, 1
    s_mov_b64 exec, 1
    s_waitcnt vmcnt(0)
    ds_add_rtn_u32 v45, v44, v45
    s_waitcnt lgkmcnt(0)
    v_readfirstlane_b32 s62, v45
    s_nop 0
    s_and_b32 s62, s62, 3
    s_cmp_lg_u32 s62, 3
    s_cbranch_scc1 mk_11
    v_mov_b32 v44, 0
    v_mov_b32 v45, s63
    buffer_store_dword v45, v44, s[72:75], s61 offen sc1
mk_11:
    s_mov_b64 exec, -1
    s_barrier
    s_lshr_b32 s37, s57, 1
    s_lshl_b32 s37, s37, 2
    s_and_b32 s39, s58, 3
    s_add_u32 s37, s37, s39
    s_and_b32 s38, s57, 1
    s_mul_i32 s38, s38, 7
    s_lshr_b32 s40, s58, 2
    s_add_u32 s38, s38, s40
    s_lshl_b32 s45, s38, 8
    s_and_b32 s43, s36, 1
    s_lshr_b32 s44, s36, 1
    v_lshrrev_b32 v4, 5, v1
    s_lshl_b32 s47, s43, 13
    v_lshlrev_b32 v19, 4, v1
    v_add_u32 v20, s47, v19
    v_bfe_u32 v5, v1, 2, 2
    v_bfe_u32 v6, v1, 4, 1
    v_lshl_add_u32 v7, v4, 2, v5
    v_lshlrev_b32 v7, 8, v7
    v_lshl_add_u32 v7, v6, 14, v7
    v_and_b32 v8, 3, v1
    v_lshl_add_u32 v7, v8, 3, v7
    v_add_u32 v7, 0x10000, v7
    v_lshl_add_u32 v5, v6, 2, v5
    s_lshl_b32 s47, s44, 2
    v_xor_b32 v5, s47, v5
    v_lshl_add_u32 v24, v5, 5, v7
    v_xor_b32 v25, 32, v24
    v_xor_b32 v26, 64, v24
    v_xor_b32 v27, 96, v24
    v_mov_b32 v128, 0
    v_mov_b32 v129, 0
    v_mov_b32 v130, 0
    v_mov_b32 v131, 0
    v_mov_b32 v132, 0
    v_mov_b32 v133, 0
    v_mov_b32 v134, 0
    v_mov_b32 v135, 0
    v_mov_b32 v136, 0
    v_mov_b32 v137, 0
    v_mov_b32 v138, 0
    v_mov_b32 v139, 0
    v_mov_b32 v140, 0
    v_mov_b32 v141, 0
    v_mov_b32 v142, 0
    v_mov_b32 v143, 0
    v_mov_b32 v144, 0
    v_mov_b32 v145, 0
    v_mov_b32 v146, 0
    v_mov_b32 v147, 0
    v_mov_b32 v148, 0
    v_mov_b32 v149, 0
    v_mov_b32 v150, 0
    v_mov_b32 v151, 0
    v_mov_b32 v152, 0
    v_mov_b32 v153, 0
    v_mov_b32 v154, 0
    v_mov_b32 v155, 0
    v_mov_b32 v156, 0
    v_mov_b32 v157, 0
    v_mov_b32 v158, 0
    v_mov_b32 v159, 0
    v_mov_b32 v160, 0
    v_mov_b32 v161, 0
    v_mov_b32 v162, 0
    v_mov_b32 v163, 0
    v_mov_b32 v164, 0
    v_mov_b32 v165, 0
    v_mov_b32 v166, 0
    v_mov_b32 v167, 0
    v_mov_b32 v168, 0
    v_mov_b32 v169, 0
    v_mov_b32 v170, 0
    v_mov_b32 v171, 0
    v_mov_b32 v172, 0
    v_mov_b32 v173, 0
    v_mov_b32 v174, 0
    v_mov_b32 v175, 0
    v_mov_b32 v176, 0
    v_mov_b32 v177, 0
    v_mov_b32 v178, 0
    v_mov_b32 v179, 0
    v_mov_b32 v180, 0
    v_mov_b32 v181, 0
    v_mov_b32 v182, 0
    v_mov_b32 v183, 0
    v_mov_b32 v184, 0
    v_mov_b32 v185, 0
    v_mov_b32 v186, 0
    v_mov_b32 v187, 0
    v_mov_b32 v188, 0
    v_mov_b32 v189, 0
    v_mov_b32 v190, 0
    v_mov_b32 v191, 0
    v_mov_b32 v192, 0
    v_mov_b32 v193, 0
    v_mov_b32 v194, 0
    v_mov_b32 v195, 0
    v_mov_b32 v196, 0
    v_mov_b32 v197, 0
    v_mov_b32 v198, 0
    v_mov_b32 v199, 0
    v_mov_b32 v200, 0
    v_mov_b32 v201, 0
    v_mov_b32 v202, 0
    v_mov_b32 v203, 0
    v_mov_b32 v204, 0
    v_mov_b32 v205, 0
    v_mov_b32 v206, 0
    v_mov_b32 v207, 0
    v_mov_b32 v208, 0
    v_mov_b32 v209, 0
    v_mov_b32 v210, 0
    v_mov_b32 v211, 0
    v_mov_b32 v212, 0
    v_mov_b32 v213, 0
    v_mov_b32 v214, 0
    v_mov_b32 v215, 0
    v_mov_b32 v216, 0
    v_mov_b32 v217, 0
    v_mov_b32 v218, 0
    v_mov_b32 v219, 0
    v_mov_b32 v220, 0
    v_mov_b32 v221, 0
    v_mov_b32 v222, 0
    v_mov_b32 v223, 0
    v_mov_b32 v224, 0
    v_mov_b32 v225, 0
    v_mov_b32 v226, 0
    v_mov_b32 v227, 0
    v_mov_b32 v228, 0
    v_mov_b32 v229, 0
    v_mov_b32 v230, 0
    v_mov_b32 v231, 0
    v_mov_b32 v232, 0
    v_mov_b32 v233, 0
    v_mov_b32 v234, 0
    v_mov_b32 v235, 0
    v_mov_b32 v236, 0
    v_mov_b32 v237, 0
    v_mov_b32 v238, 0
    v_mov_b32 v239, 0
    v_mov_b32 v240, 0
    v_mov_b32 v241, 0
    v_mov_b32 v242, 0
    v_mov_b32 v243, 0
    v_mov_b32 v244, 0
    v_mov_b32 v245, 0
    v_mov_b32 v246, 0
    v_mov_b32 v247, 0
    v_mov_b32 v248, 0
    v_mov_b32 v249, 0
    v_mov_b32 v250, 0
    v_mov_b32 v251, 0
    v_mov_b32 v252, 0
    v_mov_b32 v253, 0
    v_mov_b32 v254, 0
    v_mov_b32 v255, 0
    s_lshl_b32 s56, s37, 1
    s_add_u32 s56, s56, s43
    s_mul_i32 s56, s56, 224
    s_lshl_b32 s47, s38, 3
    s_add_u32 s56, s56, s47
    s_lshl_b32 s47, s44, 2
    s_add_u32 s56, s56, s47
    s_lshl_b32 s56, s56, 10
    s_add_u32 s56, s56, 4194304
    s_add_u32 s55, s56, 114688
    s_lshl_b32 s47, s43, 9
    s_add_u32 s47, s47, 49152
    v_lshlrev_b32 v16, 3, v1
    v_add_u32 v16, s47, v16
    s_lshl_b32 s47, s44, 8
    s_add_u32 s47, s47, 63488
    v_lshlrev_b32 v15, 4, v4
    v_add_u32 v15, s47, v15
    s_lshl_b32 s61, s37, 4
    s_add_u32 s61, s61, s38
    s_lshl_b32 s61, s61, 8
    s_add_u32 s61, s61, 38010880
    s_barrier
    s_barrier
    ds_read_b128 v[32:35], v20 offset:0
    ds_read_b64_tr_b16 v[40:41], v24 offset:0
    ds_read_b64_tr_b16 v[42:43], v24 offset:2048
    ds_read_b128 v[36:39], v20 offset:4096
    ds_read_b64_tr_b16 v[44:45], v25 offset:0
    ds_read_b64_tr_b16 v[46:47], v25 offset:2048
    ds_read_b64_tr_b16 v[48:49], v26 offset:0
    ds_read_b64_tr_b16 v[50:51], v26 offset:2048
    ds_read_b64_tr_b16 v[52:53], v27 offset:0
    ds_read_b64_tr_b16 v[54:55], v27 offset:2048
    s_mov_b32 s47, 0
    s_mov_b32 s49, 0
    s_movk_i32 s46, 0x4000
mk_p4loop:
    s_waitcnt lgkmcnt(4)
    v_mfma_f32_32x32x16_bf16 v[128:143], v[40:43], v[32:35], v[128:143]
    ds_read_b128 v[56:59], v20 offset:1024
    ds_read_b64_tr_b16 v[64:65], v24 offset:4096
    s_add_u32 s47, s47, 1
    s_add_u32 s49, s49, 1
    s_cmp_eq_u32 s49, 3
    s_cselect_b32 s49, 0, s49
    s_cselect_b32 s48, 4294934528, s46
    s_lshl_b32 s50, s48, 1
    v_mfma_f32_32x32x16_bf16 v[192:207], v[40:43], v[36:39], v[192:207]
    ds_read_b64_tr_b16 v[66:67], v24 offset:6144
    ds_read_b128 v[60:63], v20 offset:5120
    v_mfma_f32_32x32x16_bf16 v[144:159], v[44:47], v[32:35], v[144:159]
    ds_read_b64_tr_b16 v[68:69], v25 offset:4096
    ds_read_b64_tr_b16 v[70:71], v25 offset:6144
    v_mfma_f32_32x32x16_bf16 v[208:223], v[44:47], v[36:39], v[208:223]
    ds_read_b64_tr_b16 v[72:73], v26 offset:4096
    ds_read_b64_tr_b16 v[74:75], v26 offset:6144
    s_waitcnt lgkmcnt(8)
    v_mfma_f32_32x32x16_bf16 v[160:175], v[48:51], v[32:35], v[160:175]
    ds_read_b64_tr_b16 v[76:77], v27 offset:4096
    ds_read_b64_tr_b16 v[78:79], v27 offset:6144
    v_mfma_f32_32x32x16_bf16 v[224:239], v[48:51], v[36:39], v[224:239]
    v_mfma_f32_32x32x16_bf16 v[176:191], v[52:55], v[32:35], v[176:191]
    v_mfma_f32_32x32x16_bf16 v[240:255], v[52:55], v[36:39], v[240:255]
    s_waitcnt lgkmcnt(4)
    v_mfma_f32_32x32x16_bf16 v[128:143], v[64:67], v[56:59], v[128:143]
    ds_read_b128 v[32:35], v20 offset:2048
    ds_read_b64_tr_b16 v[40:41], v24 offset:8192
    v_mfma_f32_32x32x16_bf16 v[192:207], v[64:67], v[60:63], v[192:207]
    ds_read_b64_tr_b16 v[42:43], v24 offset:10240
    ds_read_b128 v[36:39], v20 offset:6144
    v_mfma_f32_32x32x16_bf16 v[144:159], v[68:71], v[56:59], v[144:159]
    ds_read_b64_tr_b16 v[44:45], v25 offset:8192
    ds_read_b64_tr_b16 v[46:47], v25 offset:10240
    v_mfma_f32_32x32x16_bf16 v[208:223], v[68:71], v[60:63], v[208:223]
    ds_read_b64_tr_b16 v[48:49], v26 offset:8192
    ds_read_b64_tr_b16 v[50:51], v26 offset:10240
    s_waitcnt lgkmcnt(8)
    v_mfma_f32_32x32x16_bf16 v[160:175], v[72:75], v[56:59], v[160:175]
    ds_read_b64_tr_b16 v[52:53], v27 offset:8192
    ds_read_b64_tr_b16 v[54:55], v27 offset:10240
    v_mfma_f32_32x32x16_bf16 v[224:239], v[72:75], v[60:63], v[224:239]
    v_mfma_f32_32x32x16_bf16 v[176:191], v[76:79], v[56:59], v[176:191]
    v_mfma_f32_32x32x16_bf16 v[240:255], v[76:79], v[60:63], v[240:255]
    s_waitcnt lgkmcnt(4)
    v_mfma_f32_32x32x16_bf16 v[128:143], v[40:43], v[32:35], v[128:143]
    ds_read_b128 v[56:59], v20 offset:3072
    ds_read_b64_tr_b16 v[64:65], v24 offset:12288
    v_mfma_f32_32x32x16_bf16 v[192:207], v[40:43], v[36:39], v[192:207]
    ds_read_b64_tr_b16 v[66:67], v24 offset:14336
    ds_read_b128 v[60:63], v20 offset:7168
    v_mfma_f32_32x32x16_bf16 v[144:159], v[44:47], v[32:35], v[144:159]
    ds_read_b64_tr_b16 v[68:69], v25 offset:12288
    ds_read_b64_tr_b16 v[70:71], v25 offset:14336
    v_mfma_f32_32x32x16_bf16 v[208:223], v[44:47], v[36:39], v[208:223]
    ds_read_b64_tr_b16 v[72:73], v26 offset:12288
    ds_read_b64_tr_b16 v[74:75], v26 offset:14336
    s_waitcnt lgkmcnt(8)
    v_mfma_f32_32x32x16_bf16 v[160:175], v[48:51], v[32:35], v[160:175]
    ds_read_b64_tr_b16 v[76:77], v27 offset:12288
    ds_read_b64_tr_b16 v[78:79], v27 offset:14336
    v_mfma_f32_32x32x16_bf16 v[224:239], v[48:51], v[36:39], v[224:239]
    v_mfma_f32_32x32x16_bf16 v[176:191], v[52:55], v[32:35], v[176:191]
    v_add_u32 v20, s48, v20
    v_add_u32 v24, s50, v24
    v_add_u32 v25, s50, v25
    v_mfma_f32_32x32x16_bf16 v[240:255], v[52:55], v[36:39], v[240:255]
    v_add_u32 v26, s50, v26
    v_add_u32 v27, s50, v27
    s_waitcnt lgkmcnt(4)
    v_mfma_f32_32x32x16_bf16 v[128:143], v[64:67], v[56:59], v[128:143]
    v_mfma_f32_32x32x16_bf16 v[192:207], v[64:67], v[60:63], v[192:207]
    s_waitcnt lgkmcnt(0)
    s_barrier
    v_mfma_f32_32x32x16_bf16 v[144:159], v[68:71], v[56:59], v[144:159]
    ds_read_b128 v[32:35], v20 offset:0
    ds_read_b64_tr_b16 v[40:41], v24 offset:0
    v_mfma_f32_32x32x16_bf16 v[208:223], v[68:71], v[60:63], v[208:223]
    ds_read_b64_tr_b16 v[42:43], v24 offset:2048
    ds_read_b128 v[36:39], v20 offset:4096
    s_waitcnt lgkmcnt(4)
    v_mfma_f32_32x32x16_bf16 v[160:175], v[72:75], v[56:59], v[160:175]
    ds_read_b64_tr_b16 v[44:45], v25 offset:0
    ds_read_b64_tr_b16 v[46:47], v25 offset:2048
    v_mfma_f32_32x32x16_bf16 v[224:239], v[72:75], v[60:63], v[224:239]
    ds_read_b64_tr_b16 v[48:49], v26 offset:0
    ds_read_b64_tr_b16 v[50:51], v26 offset:2048
    v_mfma_f32_32x32x16_bf16 v[176:191], v[76:79], v[56:59], v[176:191]
    ds_read_b64_tr_b16 v[52:53], v27 offset:0
    ds_read_b64_tr_b16 v[54:55], v27 offset:2048
    v_mfma_f32_32x32x16_bf16 v[240:255], v[76:79], v[60:63], v[240:255]
    s_cmp_lt_u32 s47, 6
    s_cbranch_scc1 mk_p4loop
    s_waitcnt lgkmcnt(4)
    v_mfma_f32_32x32x16_bf16 v[128:143], v[40:43], v[32:35], v[128:143]
    ds_read_b128 v[56:59], v20 offset:1024
    ds_read_b64_tr_b16 v[64:65], v24 offset:4096
    v_mfma_f32_32x32x16_bf16 v[192:207], v[40:43], v[36:39], v[192:207]
    ds_read_b64_tr_b16 v[66:67], v24 offset:6144
    ds_read_b128 v[60:63], v20 offset:5120
    v_mfma_f32_32x32x16_bf16 v[144:159], v[44:47], v[32:35], v[144:159]
    ds_read_b64_tr_b16 v[68:69], v25 offset:4096
    ds_read_b64_tr_b16 v[70:71], v25 offset:6144
    v_mfma_f32_32x32x16_bf16 v[208:223], v[44:47], v[36:39], v[208:223]
    ds_read_b64_tr_b16 v[72:73], v26 offset:4096
    ds_read_b64_tr_b16 v[74:75], v26 offset:6144
    s_waitcnt lgkmcnt(8)
    v_mfma_f32_32x32x16_bf16 v[160:175], v[48:51], v[32:35], v[160:175]
    ds_read_b64_tr_b16 v[76:77], v27 offset:4096
    ds_read_b64_tr_b16 v[78:79], v27 offset:6144
    v_mfma_f32_32x32x16_bf16 v[224:239], v[48:51], v[36:39], v[224:239]
    ds_read2st64_b64 v[80:83], v16 offset0:0 offset1:2
    ds_read2st64_b64 v[84:87], v16 offset0:4 offset1:6
    v_mfma_f32_32x32x16_bf16 v[176:191], v[52:55], v[32:35], v[176:191]
    ds_read2st64_b64 v[88:91], v16 offset0:8 offset1:10
    ds_read2st64_b64 v[92:95], v16 offset0:12 offset1:14
    v_mfma_f32_32x32x16_bf16 v[240:255], v[52:55], v[36:39], v[240:255]
    ds_read2st64_b64 v[96:99], v16 offset0:16 offset1:18
    ds_read2st64_b64 v[100:103], v16 offset0:20 offset1:22
    s_waitcnt lgkmcnt(10)
    v_mfma_f32_32x32x16_bf16 v[128:143], v[64:67], v[56:59], v[128:143]
    ds_read2st64_b64 v[104:107], v16 offset0:24 offset1:26
    ds_read_b128 v[32:35], v20 offset:2048
    v_mfma_f32_32x32x16_bf16 v[192:207], v[64:67], v[60:63], v[192:207]
    ds_read_b64_tr_b16 v[40:41], v24 offset:8192
    ds_read_b64_tr_b16 v[42:43], v24 offset:10240
    v_mfma_f32_32x32x16_bf16 v[144:159], v[68:71], v[56:59], v[144:159]
    ds_read_b128 v[36:39], v20 offset:6144
    ds_read_b64_tr_b16 v[44:45], v25 offset:8192
    v_mfma_f32_32x32x16_bf16 v[208:223], v[68:71], v[60:63], v[208:223]
    ds_read_b64_tr_b16 v[46:47], v25 offset:10240
    ds_read_b64_tr_b16 v[48:49], v26 offset:8192
    s_waitcnt lgkmcnt(7)
    v_add_f32 v80, v80, v94
    v_add_f32 v81, v81, v95
    v_add_f32 v82, v82, v96
    s_waitcnt lgkmcnt(14)
    v_mfma_f32_32x32x16_bf16 v[160:175], v[72:75], v[56:59], v[160:175]
    ds_read_b64_tr_b16 v[50:51], v26 offset:10240
    ds_read_b64_tr_b16 v[52:53], v27 offset:8192
    v_add_f32 v83, v83, v97
    v_add_f32 v84, v84, v98
    v_add_f32 v85, v85, v99
    v_mfma_f32_32x32x16_bf16 v[224:239], v[72:75], v[60:63], v[224:239]
    ds_read_b64_tr_b16 v[54:55], v27 offset:10240
    v_add_f32 v86, v86, v100
    v_add_f32 v87, v87, v101
    v_add_f32 v88, v88, v102
    v_mfma_f32_32x32x16_bf16 v[176:191], v[76:79], v[56:59], v[176:191]
    v_add_f32 v89, v89, v103
    v_add_f32 v90, v90, v104
    v_add_f32 v91, v91, v105
    v_add_f32 v92, v92, v106
    v_mfma_f32_32x32x16_bf16 v[240:255], v[76:79], v[60:63], v[240:255]
    v_add_f32 v93, v93, v107
    v_add_f32 v80, v80, v86
    v_add_f32 v81, v81, v87
    v_add_f32 v82, v82, v88
    s_waitcnt lgkmcnt(4)
    v_mfma_f32_32x32x16_bf16 v[128:143], v[40:43], v[32:35], v[128:143]
    ds_read_b128 v[56:59], v20 offset:3072
    ds_read_b64_tr_b16 v[64:65], v24 offset:12288
    v_add_f32 v83, v83, v89
    v_add_f32 v84, v84, v90
    v_add_f32 v85, v85, v91
    v_mfma_f32_32x32x16_bf16 v[192:207], v[40:43], v[36:39], v[192:207]
    ds_read_b64_tr_b16 v[66:67], v24 offset:14336
    ds_read_b128 v[60:63], v20 offset:7168
    v_add_f32 v80, v80, v92
    v_add_f32 v81, v81, v93
    v_add_f32 v82, v82, v84
    v_mfma_f32_32x32x16_bf16 v[144:159], v[44:47], v[32:35], v[144:159]
    ds_read_b64_tr_b16 v[68:69], v25 offset:12288
    ds_read_b64_tr_b16 v[70:71], v25 offset:14336
    v_add_f32 v83, v83, v85
    v_add_f32 v80, v80, v82
    v_add_f32 v81, v81, v83
    v_mfma_f32_32x32x16_bf16 v[208:223], v[44:47], v[36:39], v[208:223]
    ds_read_b64_tr_b16 v[72:73], v26 offset:12288
    ds_read_b64_tr_b16 v[74:75], v26 offset:14336
    v_mul_f32 v120, 0xbb124925, v80
    v_mul_f32 v122, 0x3b124925, v81
    v_fma_f32 v122, -v120, v120, v122
    s_waitcnt lgkmcnt(8)
    v_mfma_f32_32x32x16_bf16 v[160:175], v[48:51], v[32:35], v[160:175]
    ds_read_b64_tr_b16 v[76:77], v27 offset:12288
    ds_read_b64_tr_b16 v[78:79], v27 offset:14336
    v_mov_b32 v121, v120
    v_max_f32 v122, 0, v122
    v_add_f32 v122, 0x3727c5ac, v122
    v_mfma_f32_32x32x16_bf16 v[224:239], v[48:51], v[36:39], v[224:239]
    v_permlane32_swap_b32 v120, v121
    v_rsq_f32 v13, v122
    v_mov_b32 v123, v122
    v_mfma_f32_32x32x16_bf16 v[176:191], v[52:55], v[32:35], v[176:191]
    v_mul_f32 v124, 0xc0135761, v13
    v_mul_f32 v14, v13, v13
    v_mul_f32 v14, v14, v124
    v_mfma_f32_32x32x16_bf16 v[240:255], v[52:55], v[36:39], v[240:255]
    v_mul_f32 v126, 0x3d372713, v14
    v_mov_b32 v125, v124
    v_mov_b32 v127, v126
    s_waitcnt lgkmcnt(4)
    v_mfma_f32_32x32x16_bf16 v[128:143], v[64:67], v[56:59], v[128:143]
    ds_read_b128 v[84:87], v15 offset:0
    ds_read_b128 v[88:91], v15 offset:32
    v_permlane32_swap_b32 v122, v123
    v_permlane32_swap_b32 v124, v125
    v_permlane32_swap_b32 v126, v127
    v_mfma_f32_32x32x16_bf16 v[192:207], v[64:67], v[60:63], v[192:207]
    ds_read_b128 v[92:95], v15 offset:512
    ds_read_b128 v[96:99], v15 offset:544
    v_mov_b32 v5, 163836
    v_mov_b32 v6, 0
    v_mfma_f32_32x32x16_bf16 v[144:159], v[68:71], v[56:59], v[144:159]
    ds_read_b128 v[32:35], v15 offset:64
    ds_read_b128 v[36:39], v15 offset:96
    v_mfma_f32_32x32x16_bf16 v[208:223], v[68:71], v[60:63], v[208:223]
    ds_read_b128 v[40:43], v15 offset:576
    ds_read_b128 v[44:47], v15 offset:608
    s_waitcnt lgkmcnt(8)
    v_mfma_f32_32x32x16_bf16 v[160:175], v[72:75], v[56:59], v[160:175]
    ds_write_b32 v5, v6
    v_mfma_f32_32x32x16_bf16 v[224:239], v[72:75], v[60:63], v[224:239]
    v_mfma_f32_32x32x16_bf16 v[176:191], v[76:79], v[56:59], v[176:191]
    v_mfma_f32_32x32x16_bf16 v[240:255], v[76:79], v[60:63], v[240:255]
    ds_read_b128 v[48:51], v15 offset:128
    ds_read_b128 v[52:55], v15 offset:160
    ds_read_b128 v[56:59], v15 offset:640
    ds_read_b128 v[60:63], v15 offset:672
    ds_read_b128 v[64:67], v15 offset:192
    ds_read_b128 v[68:71], v15 offset:224
    ds_read_b128 v[72:75], v15 offset:704
    ds_read_b128 v[76:79], v15 offset:736
    s_waitcnt lgkmcnt(13)
    v_pk_fma_f32 v[128:129], v[84:85], v[120:121], v[128:129] op_sel_hi:[1,0,1]
    v_pk_fma_f32 v[130:131], v[86:87], v[120:121], v[130:131] op_sel_hi:[1,0,1]
    v_pk_fma_f32 v[132:133], v[88:89], v[120:121], v[132:133] op_sel_hi:[1,0,1]
    v_pk_fma_f32 v[134:135], v[90:91], v[120:121], v[134:135] op_sel_hi:[1,0,1]
    v_pk_fma_f32 v[136:137], v[92:93], v[120:121], v[136:137] op_sel_hi:[1,0,1]
    v_pk_fma_f32 v[138:139], v[94:95], v[120:121], v[138:139] op_sel_hi:[1,0,1]
    v_pk_fma_f32 v[140:141], v[96:97], v[120:121], v[140:141] op_sel_hi:[1,0,1]
    v_pk_fma_f32 v[142:143], v[98:99], v[120:121], v[142:143] op_sel_hi:[1,0,1]
    v_pk_mul_f32 v[100:101], v[128:129], v[128:129]
    v_pk_mul_f32 v[102:103], v[130:131], v[130:131]
    v_pk_mul_f32 v[104:105], v[132:133], v[132:133]
    v_pk_mul_f32 v[106:107], v[134:135], v[134:135]
    v_pk_fma_f32 v[100:101], v[100:101], v[126:127], v[124:125] op_sel_hi:[1,0,0]
    v_pk_fma_f32 v[102:103], v[102:103], v[126:127], v[124:125] op_sel_hi:[1,0,0]
    v_pk_fma_f32 v[104:105], v[104:105], v[126:127], v[124:125] op_sel_hi:[1,0,0]
    v_pk_fma_f32 v[106:107], v[106:107], v[126:127], v[124:125] op_sel_hi:[1,0,0]
    v_pk_mul_f32 v[100:101], v[100:101], v[128:129]
    v_pk_mul_f32 v[102:103], v[102:103], v[130:131]
    v_pk_mul_f32 v[104:105], v[104:105], v[132:133]
    v_pk_mul_f32 v[106:107], v[106:107], v[134:135]
    v_exp_f32 v100, v100
    v_exp_f32 v101, v101
    v_exp_f32 v102, v102
    v_exp_f32 v103, v103
    v_exp_f32 v104, v104
    v_exp_f32 v105, v105
    v_exp_f32 v106, v106
    v_exp_f32 v107, v107
    v_pk_mul_f32 v[128:129], v[128:129], v[136:137]
    v_pk_mul_f32 v[130:131], v[130:131], v[138:139]
    v_pk_mul_f32 v[132:133], v[132:133], v[140:141]
    v_pk_mul_f32 v[134:135], v[134:135], v[142:143]
    v_pk_fma_f32 v[100:101], v[100:101], v[122:123], v[122:123] op_sel_hi:[1,0,0]
    v_pk_fma_f32 v[102:103], v[102:103], v[122:123], v[122:123] op_sel_hi:[1,0,0]
    v_pk_fma_f32 v[104:105], v[104:105], v[122:123], v[122:123] op_sel_hi:[1,0,0]
    v_pk_fma_f32 v[106:107], v[106:107], v[122:123], v[122:123] op_sel_hi:[1,0,0]
    v_rcp_f32 v100, v100
    v_rcp_f32 v101, v101
    v_rcp_f32 v102, v102
    v_rcp_f32 v103, v103
    v_rcp_f32 v104, v104
    v_rcp_f32 v105, v105
    v_rcp_f32 v106, v106
    v_rcp_f32 v107, v107
    v_pk_mul_f32 v[128:129], v[128:129], v[100:101]
    v_pk_mul_f32 v[130:131], v[130:131], v[102:103]
    v_pk_mul_f32 v[132:133], v[132:133], v[104:105]
    v_pk_mul_f32 v[134:135], v[134:135], v[106:107]
    v_cvt_pk_bf16_f32 v136, v128, v129
    v_cvt_pk_bf16_f32 v137, v130, v131
    v_cvt_pk_bf16_f32 v138, v132, v133
    v_cvt_pk_bf16_f32 v139, v134, v135
    buffer_store_dwordx4 v[136:139], v19, s[72:75], s56 offen offset:0 sc1
    s_waitcnt lgkmcnt(0)
    s_barrier
    v_pk_fma_f32 v[192:193], v[84:85], v[120:121], v[192:193] op_sel:[0,1,0] op_sel_hi:[1,1,1]
    v_pk_fma_f32 v[194:195], v[86:87], v[120:121], v[194:195] op_sel:[0,1,0] op_sel_hi:[1,1,1]
    v_pk_fma_f32 v[196:197], v[88:89], v[120:121], v[196:197] op_sel:[0,1,0] op_sel_hi:[1,1,1]
    v_pk_fma_f32 v[198:199], v[90:91], v[120:121], v[198:199] op_sel:[0,1,0] op_sel_hi:[1,1,1]
    v_pk_fma_f32 v[200:201], v[92:93], v[120:121], v[200:201] op_sel:[0,1,0] op_sel_hi:[1,1,1]
    v_pk_fma_f32 v[202:203], v[94:95], v[120:121], v[202:203] op_sel:[0,1,0] op_sel_hi:[1,1,1]
    v_pk_fma_f32 v[204:205], v[96:97], v[120:121], v[204:205] op_sel:[0,1,0] op_sel_hi:[1,1,1]
    v_pk_fma_f32 v[206:207], v[98:99], v[120:121], v[206:207] op_sel:[0,1,0] op_sel_hi:[1,1,1]
    v_pk_mul_f32 v[100:101], v[192:193], v[192:193]
    v_pk_mul_f32 v[102:103], v[194:195], v[194:195]
    v_pk_mul_f32 v[104:105], v[196:197], v[196:197]
    v_pk_mul_f32 v[106:107], v[198:199], v[198:199]
    v_pk_fma_f32 v[100:101], v[100:101], v[126:127], v[124:125] op_sel:[0,1,1] op_sel_hi:[1,1,1]
    v_pk_fma_f32 v[102:103], v[102:103], v[126:127], v[124:125] op_sel:[0,1,1] op_sel_hi:[1,1,1]
    v_pk_fma_f32 v[104:105], v[104:105], v[126:127], v[124:125] op_sel:[0,1,1] op_sel_hi:[1,1,1]
    v_pk_fma_f32 v[106:107], v[106:107], v[126:127], v[124:125] op_sel:[0,1,1] op_sel_hi:[1,1,1]
    v_pk_mul_f32 v[100:101], v[100:101], v[192:193]
    v_pk_mul_f32 v[102:103], v[102:103], v[194:195]
    v_pk_mul_f32 v[104:105], v[104:105], v[196:197]
    v_pk_mul_f32 v[106:107], v[106:107], v[198:199]
    v_exp_f32 v100, v100
    v_exp_f32 v101, v101
    v_exp_f32 v102, v102
    v_exp_f32 v103, v103
    v_exp_f32 v104, v104
    v_exp_f32 v105, v105
    v_exp_f32 v106, v106
    v_exp_f32 v107, v107
    v_pk_mul_f32 v[192:193], v[192:193], v[200:201]
    v_pk_mul_f32 v[194:195], v[194:195], v[202:203]
    v_pk_mul_f32 v[196:197], v[196:197], v[204:205]
    v_pk_mul_f32 v[198:199], v[198:199], v[206:207]
    v_pk_fma_f32 v[100:101], v[100:101], v[122:123], v[122:123] op_sel:[0,1,1] op_sel_hi:[1,1,1]
    v_pk_fma_f32 v[102:103], v[102:103], v[122:123], v[122:123] op_sel:[0,1,1] op_sel_hi:[1,1,1]
    v_pk_fma_f32 v[104:105], v[104:105], v[122:123], v[122:123] op_sel:[0,1,1] op_sel_hi:[1,1,1]
    v_pk_fma_f32 v[106:107], v[106:107], v[122:123], v[122:123] op_sel:[0,1,1] op_sel_hi:[1,1,1]
    v_rcp_f32 v100, v100
    v_rcp_f32 v101, v101
    v_rcp_f32 v102, v102
    v_rcp_f32 v103, v103
    v_rcp_f32 v104, v104
    v_rcp_f32 v105, v105
    v_rcp_f32 v106, v106
    v_rcp_f32 v107, v107
    v_pk_mul_f32 v[192:193], v[192:193], v[100:101]
    v_pk_mul_f32 v[194:195], v[194:195], v[102:103]
    v_pk_mul_f32 v[196:197], v[196:197], v[104:105]
    v_pk_mul_f32 v[198:199], v[198:199], v[106:107]
    v_cvt_pk_bf16_f32 v200, v192, v193
    v_cvt_pk_bf16_f32 v201, v194, v195
    v_cvt_pk_bf16_f32 v202, v196, v197
    v_cvt_pk_bf16_f32 v203, v198, v199
    buffer_store_dwordx4 v[200:203], v19, s[72:75], s55 offen offset:0 sc1
    v_pk_fma_f32 v[144:145], v[32:33], v[120:121], v[144:145] op_sel_hi:[1,0,1]
    v_pk_fma_f32 v[146:147], v[34:35], v[120:121], v[146:147] op_sel_hi:[1,0,1]
    v_pk_fma_f32 v[148:149], v[36:37], v[120:121], v[148:149] op_sel_hi:[1,0,1]
    v_pk_fma_f32 v[150:151], v[38:39], v[120:121], v[150:151] op_sel_hi:[1,0,1]
    v_pk_fma_f32 v[152:153], v[40:41], v[120:121], v[152:153] op_sel_hi:[1,0,1]
    v_pk_fma_f32 v[154:155], v[42:43], v[120:121], v[154:155] op_sel_hi:[1,0,1]
    v_pk_fma_f32 v[156:157], v[44:45], v[120:121], v[156:157] op_sel_hi:[1,0,1]
    v_pk_fma_f32 v[158:159], v[46:47], v[120:121], v[158:159] op_sel_hi:[1,0,1]
    v_pk_mul_f32 v[100:101], v[144:145], v[144:145]
    v_pk_mul_f32 v[102:103], v[146:147], v[146:147]
    v_pk_mul_f32 v[104:105], v[148:149], v[148:149]
    v_pk_mul_f32 v[106:107], v[150:151], v[150:151]
    v_pk_fma_f32 v[100:101], v[100:101], v[126:127], v[124:125] op_sel_hi:[1,0,0]
    v_pk_fma_f32 v[102:103], v[102:103], v[126:127], v[124:125] op_sel_hi:[1,0,0]
    v_pk_fma_f32 v[104:105], v[104:105], v[126:127], v[124:125] op_sel_hi:[1,0,0]
    v_pk_fma_f32 v[106:107], v[106:107], v[126:127], v[124:125] op_sel_hi:[1,0,0]
    v_pk_mul_f32 v[100:101], v[100:101], v[144:145]
    v_pk_mul_f32 v[102:103], v[102:103], v[146:147]
    v_pk_mul_f32 v[104:105], v[104:105], v[148:149]
    v_pk_mul_f32 v[106:107], v[106:107], v[150:151]
    v_exp_f32 v100, v100
    v_exp_f32 v101, v101
    v_exp_f32 v102, v102
    v_exp_f32 v103, v103
    v_exp_f32 v104, v104
    v_exp_f32 v105, v105
    v_exp_f32 v106, v106
    v_exp_f32 v107, v107
    v_pk_mul_f32 v[144:145], v[144:145], v[152:153]
    v_pk_mul_f32 v[146:147], v[146:147], v[154:155]
    v_pk_mul_f32 v[148:149], v[148:149], v[156:157]
    v_pk_mul_f32 v[150:151], v[150:151], v[158:159]
    v_pk_fma_f32 v[100:101], v[100:101], v[122:123], v[122:123] op_sel_hi:[1,0,0]
    v_pk_fma_f32 v[102:103], v[102:103], v[122:123], v[122:123] op_sel_hi:[1,0,0]
    v_pk_fma_f32 v[104:105], v[104:105], v[122:123], v[122:123] op_sel_hi:[1,0,0]
    v_pk_fma_f32 v[106:107], v[106:107], v[122:123], v[122:123] op_sel_hi:[1,0,0]
    v_rcp_f32 v100, v100
    v_rcp_f32 v101, v101
    v_rcp_f32 v102, v102
    v_rcp_f32 v103, v103
    v_rcp_f32 v104, v104
    v_rcp_f32 v105, v105
    v_rcp_f32 v106, v106
    v_rcp_f32 v107, v107
    v_pk_mul_f32 v[144:145], v[144:145], v[100:101]
    v_pk_mul_f32 v[146:147], v[146:147], v[102:103]
    v_pk_mul_f32 v[148:149], v[148:149], v[104:105]
    v_pk_mul_f32 v[150:151], v[150:151], v[106:107]
    v_cvt_pk_bf16_f32 v152, v144, v145
    v_cvt_pk_bf16_f32 v153, v146, v147
    v_cvt_pk_bf16_f32 v154, v148, v149
    v_cvt_pk_bf16_f32 v155, v150, v151
    buffer_store_dwordx4 v[152:155], v19, s[72:75], s56 offen offset:1024 sc1
    v_pk_fma_f32 v[208:209], v[32:33], v[120:121], v[208:209] op_sel:[0,1,0] op_sel_hi:[1,1,1]
    v_pk_fma_f32 v[210:211], v[34:35], v[120:121], v[210:211] op_sel:[0,1,0] op_sel_hi:[1,1,1]
    v_pk_fma_f32 v[212:213], v[36:37], v[120:121], v[212:213] op_sel:[0,1,0] op_sel_hi:[1,1,1]
    v_pk_fma_f32 v[214:215], v[38:39], v[120:121], v[214:215] op_sel:[0,1,0] op_sel_hi:[1,1,1]
    v_pk_fma_f32 v[216:217], v[40:41], v[120:121], v[216:217] op_sel:[0,1,0] op_sel_hi:[1,1,1]
    v_pk_fma_f32 v[218:219], v[42:43], v[120:121], v[218:219] op_sel:[0,1,0] op_sel_hi:[1,1,1]
    v_pk_fma_f32 v[220:221], v[44:45], v[120:121], v[220:221] op_sel:[0,1,0] op_sel_hi:[1,1,1]
    v_pk_fma_f32 v[222:223], v[46:47], v[120:121], v[222:223] op_sel:[0,1,0] op_sel_hi:[1,1,1]
    v_pk_mul_f32 v[100:101], v[208:209], v[208:209]
    v_pk_mul_f32 v[102:103], v[210:211], v[210:211]
    v_pk_mul_f32 v[104:105], v[212:213], v[212:213]
    v_pk_mul_f32 v[106:107], v[214:215], v[214:215]
    v_pk_fma_f32 v[100:101], v[100:101], v[126:127], v[124:125] op_sel:[0,1,1] op_sel_hi:[1,1,1]
    v_pk_fma_f32 v[102:103], v[102:103], v[126:127], v[124:125] op_sel:[0,1,1] op_sel_hi:[1,1,1]
    v_pk_fma_f32 v[104:105], v[104:105], v[126:127], v[124:125] op_sel:[0,1,1] op_sel_hi:[1,1,1]
    v_pk_fma_f32 v[106:107], v[106:107], v[126:127], v[124:125] op_sel:[0,1,1] op_sel_hi:[1,1,1]
    v_pk_mul_f32 v[100:101], v[100:101], v[208:209]
    v_pk_mul_f32 v[102:103], v[102:103], v[210:211]
    v_pk_mul_f32 v[104:105], v[104:105], v[212:213]
    v_pk_mul_f32 v[106:107], v[106:107], v[214:215]
    v_exp_f32 v100, v100
    v_exp_f32 v101, v101
    v_exp_f32 v102, v102
    v_exp_f32 v103, v103
    v_exp_f32 v104, v104
    v_exp_f32 v105, v105
    v_exp_f32 v106, v106
    v_exp_f32 v107, v107
    v_pk_mul_f32 v[208:209], v[208:209], v[216:217]
    v_pk_mul_f32 v[210:211], v[210:211], v[218:219]
    v_pk_mul_f32 v[212:213], v[212:213], v[220:221]
    v_pk_mul_f32 v[214:215], v[214:215], v[222:223]
    v_pk_fma_f32 v[100:101], v[100:101], v[122:123], v[122:123] op_sel:[0,1,1] op_sel_hi:[1,1,1]
    v_pk_fma_f32 v[102:103], v[102:103], v[122:123], v[122:123] op_sel:[0,1,1] op_sel_hi:[1,1,1]
    v_pk_fma_f32 v[104:105], v[104:105], v[122:123], v[122:123] op_sel:[0,1,1] op_sel_hi:[1,1,1]
    v_pk_fma_f32 v[106:107], v[106:107], v[122:123], v[122:123] op_sel:[0,1,1] op_sel_hi:[1,1,1]
    v_rcp_f32 v100, v100
    v_rcp_f32 v101, v101
    v_rcp_f32 v102, v102
    v_rcp_f32 v103, v103
    v_rcp_f32 v104, v104
    v_rcp_f32 v105, v105
    v_rcp_f32 v106, v106
    v_rcp_f32 v107, v107
    v_pk_mul_f32 v[208:209], v[208:209], v[100:101]
    v_pk_mul_f32 v[210:211], v[210:211], v[102:103]
    v_pk_mul_f32 v[212:213], v[212:213], v[104:105]
    v_pk_mul_f32 v[214:215], v[214:215], v[106:107]
    v_cvt_pk_bf16_f32 v216, v208, v209
    v_cvt_pk_bf16_f32 v217, v210, v211
    v_cvt_pk_bf16_f32 v218, v212, v213
    v_cvt_pk_bf16_f32 v219, v214, v215
    buffer_store_dwordx4 v[216:219], v19, s[72:75], s55 offen offset:1024 sc1
    v_pk_fma_f32 v[160:161], v[48:49], v[120:121], v[160:161] op_sel_hi:[1,0,1]
    v_pk_fma_f32 v[162:163], v[50:51], v[120:121], v[162:163] op_sel_hi:[1,0,1]
    v_pk_fma_f32 v[164:165], v[52:53], v[120:121], v[164:165] op_sel_hi:[1,0,1]
    v_pk_fma_f32 v[166:167], v[54:55], v[120:121], v[166:167] op_sel_hi:[1,0,1]
    v_pk_fma_f32 v[168:169], v[56:57], v[120:121], v[168:169] op_sel_hi:[1,0,1]
    v_pk_fma_f32 v[170:171], v[58:59], v[120:121], v[170:171] op_sel_hi:[1,0,1]
    v_pk_fma_f32 v[172:173], v[60:61], v[120:121], v[172:173] op_sel_hi:[1,0,1]
    v_pk_fma_f32 v[174:175], v[62:63], v[120:121], v[174:175] op_sel_hi:[1,0,1]
    v_pk_mul_f32 v[100:101], v[160:161], v[160:161]
    v_pk_mul_f32 v[102:103], v[162:163], v[162:163]
    v_pk_mul_f32 v[104:105], v[164:165], v[164:165]
    v_pk_mul_f32 v[106:107], v[166:167], v[166:167]
    v_pk_fma_f32 v[100:101], v[100:101], v[126:127], v[124:125] op_sel_hi:[1,0,0]
    v_pk_fma_f32 v[102:103], v[102:103], v[126:127], v[124:125] op_sel_hi:[1,0,0]
    v_pk_fma_f32 v[104:105], v[104:105], v[126:127], v[124:125] op_sel_hi:[1,0,0]
    v_pk_fma_f32 v[106:107], v[106:107], v[126:127], v[124:125] op_sel_hi:[1,0,0]
    v_pk_mul_f32 v[100:101], v[100:101], v[160:161]
    v_pk_mul_f32 v[102:103], v[102:103], v[162:163]
    v_pk_mul_f32 v[104:105], v[104:105], v[164:165]
    v_pk_mul_f32 v[106:107], v[106:107], v[166:167]
    v_exp_f32 v100, v100
    v_exp_f32 v101, v101
    v_exp_f32 v102, v102
    v_exp_f32 v103, v103
    v_exp_f32 v104, v104
    v_exp_f32 v105, v105
    v_exp_f32 v106, v106
    v_exp_f32 v107, v107
    v_pk_mul_f32 v[160:161], v[160:161], v[168:169]
    v_pk_mul_f32 v[162:163], v[162:163], v[170:171]
    v_pk_mul_f32 v[164:165], v[164:165], v[172:173]
    v_pk_mul_f32 v[166:167], v[166:167], v[174:175]
    v_pk_fma_f32 v[100:101], v[100:101], v[122:123], v[122:123] op_sel_hi:[1,0,0]
    v_pk_fma_f32 v[102:103], v[102:103], v[122:123], v[122:123] op_sel_hi:[1,0,0]
    v_pk_fma_f32 v[104:105], v[104:105], v[122:123], v[122:123] op_sel_hi:[1,0,0]
    v_pk_fma_f32 v[106:107], v[106:107], v[122:123], v[122:123] op_sel_hi:[1,0,0]
    v_rcp_f32 v100, v100
    v_rcp_f32 v101, v101
    v_rcp_f32 v102, v102
    v_rcp_f32 v103, v103
    v_rcp_f32 v104, v104
    v_rcp_f32 v105, v105
    v_rcp_f32 v106, v106
    v_rcp_f32 v107, v107
    v_pk_mul_f32 v[160:161], v[160:161], v[100:101]
    v_pk_mul_f32 v[162:163], v[162:163], v[102:103]
    v_pk_mul_f32 v[164:165], v[164:165], v[104:105]
    v_pk_mul_f32 v[166:167], v[166:167], v[106:107]
    v_cvt_pk_bf16_f32 v168, v160, v161
    v_cvt_pk_bf16_f32 v169, v162, v163
    v_cvt_pk_bf16_f32 v170, v164, v165
    v_cvt_pk_bf16_f32 v171, v166, v167
    buffer_store_dwordx4 v[168:171], v19, s[72:75], s56 offen offset:2048 sc1
    v_pk_fma_f32 v[224:225], v[48:49], v[120:121], v[224:225] op_sel:[0,1,0] op_sel_hi:[1,1,1]
    v_pk_fma_f32 v[226:227], v[50:51], v[120:121], v[226:227] op_sel:[0,1,0] op_sel_hi:[1,1,1]
    v_pk_fma_f32 v[228:229], v[52:53], v[120:121], v[228:229] op_sel:[0,1,0] op_sel_hi:[1,1,1]
    v_pk_fma_f32 v[230:231], v[54:55], v[120:121], v[230:231] op_sel:[0,1,0] op_sel_hi:[1,1,1]
    v_pk_fma_f32 v[232:233], v[56:57], v[120:121], v[232:233] op_sel:[0,1,0] op_sel_hi:[1,1,1]
    v_pk_fma_f32 v[234:235], v[58:59], v[120:121], v[234:235] op_sel:[0,1,0] op_sel_hi:[1,1,1]
    v_pk_fma_f32 v[236:237], v[60:61], v[120:121], v[236:237] op_sel:[0,1,0] op_sel_hi:[1,1,1]
    v_pk_fma_f32 v[238:239], v[62:63], v[120:121], v[238:239] op_sel:[0,1,0] op_sel_hi:[1,1,1]
    v_pk_mul_f32 v[100:101], v[224:225], v[224:225]
    v_pk_mul_f32 v[102:103], v[226:227], v[226:227]
    v_pk_mul_f32 v[104:105], v[228:229], v[228:229]
    v_pk_mul_f32 v[106:107], v[230:231], v[230:231]
    v_pk_fma_f32 v[100:101], v[100:101], v[126:127], v[124:125] op_sel:[0,1,1] op_sel_hi:[1,1,1]
    v_pk_fma_f32 v[102:103], v[102:103], v[126:127], v[124:125] op_sel:[0,1,1] op_sel_hi:[1,1,1]
    v_pk_fma_f32 v[104:105], v[104:105], v[126:127], v[124:125] op_sel:[0,1,1] op_sel_hi:[1,1,1]
    v_pk_fma_f32 v[106:107], v[106:107], v[126:127], v[124:125] op_sel:[0,1,1] op_sel_hi:[1,1,1]
    v_pk_mul_f32 v[100:101], v[100:101], v[224:225]
    v_pk_mul_f32 v[102:103], v[102:103], v[226:227]
    v_pk_mul_f32 v[104:105], v[104:105], v[228:229]
    v_pk_mul_f32 v[106:107], v[106:107], v[230:231]
    v_exp_f32 v100, v100
    v_exp_f32 v101, v101
    v_exp_f32 v102, v102
    v_exp_f32 v103, v103
    v_exp_f32 v104, v104
    v_exp_f32 v105, v105
    v_exp_f32 v106, v106
    v_exp_f32 v107, v107
    v_pk_mul_f32 v[224:225], v[224:225], v[232:233]
    v_pk_mul_f32 v[226:227], v[226:227], v[234:235]
    v_pk_mul_f32 v[228:229], v[228:229], v[236:237]
    v_pk_mul_f32 v[230:231], v[230:231], v[238:239]
    v_pk_fma_f32 v[100:101], v[100:101], v[122:123], v[122:123] op_sel:[0,1,1] op_sel_hi:[1,1,1]
    v_pk_fma_f32 v[102:103], v[102:103], v[122:123], v[122:123] op_sel:[0,1,1] op_sel_hi:[1,1,1]
    v_pk_fma_f32 v[104:105], v[104:105], v[122:123], v[122:123] op_sel:[0,1,1] op_sel_hi:[1,1,1]
    v_pk_fma_f32 v[106:107], v[106:107], v[122:123], v[122:123] op_sel:[0,1,1] op_sel_hi:[1,1,1]
    v_rcp_f32 v100, v100
    v_rcp_f32 v101, v101
    v_rcp_f32 v102, v102
    v_rcp_f32 v103, v103
    v_rcp_f32 v104, v104
    v_rcp_f32 v105, v105
    v_rcp_f32 v106, v106
    v_rcp_f32 v107, v107
    v_pk_mul_f32 v[224:225], v[224:225], v[100:101]
    v_pk_mul_f32 v[226:227], v[226:227], v[102:103]
    v_pk_mul_f32 v[228:229], v[228:229], v[104:105]
    v_pk_mul_f32 v[230:231], v[230:231], v[106:107]
    v_cvt_pk_bf16_f32 v232, v224, v225
    v_cvt_pk_bf16_f32 v233, v226, v227
    v_cvt_pk_bf16_f32 v234, v228, v229
    v_cvt_pk_bf16_f32 v235, v230, v231
    buffer_store_dwordx4 v[232:235], v19, s[72:75], s55 offen offset:2048 sc1
    v_pk_fma_f32 v[176:177], v[64:65], v[120:121], v[176:177] op_sel_hi:[1,0,1]
    v_pk_fma_f32 v[178:179], v[66:67], v[120:121], v[178:179] op_sel_hi:[1,0,1]
    v_pk_fma_f32 v[180:181], v[68:69], v[120:121], v[180:181] op_sel_hi:[1,0,1]
    v_pk_fma_f32 v[182:183], v[70:71], v[120:121], v[182:183] op_sel_hi:[1,0,1]
    v_pk_fma_f32 v[184:185], v[72:73], v[120:121], v[184:185] op_sel_hi:[1,0,1]
    v_pk_fma_f32 v[186:187], v[74:75], v[120:121], v[186:187] op_sel_hi:[1,0,1]
    v_pk_fma_f32 v[188:189], v[76:77], v[120:121], v[188:189] op_sel_hi:[1,0,1]
    v_pk_fma_f32 v[190:191], v[78:79], v[120:121], v[190:191] op_sel_hi:[1,0,1]
    v_pk_mul_f32 v[100:101], v[176:177], v[176:177]
    v_pk_mul_f32 v[102:103], v[178:179], v[178:179]
    v_pk_mul_f32 v[104:105], v[180:181], v[180:181]
    v_pk_mul_f32 v[106:107], v[182:183], v[182:183]
    v_pk_fma_f32 v[100:101], v[100:101], v[126:127], v[124:125] op_sel_hi:[1,0,0]
    v_pk_fma_f32 v[102:103], v[102:103], v[126:127], v[124:125] op_sel_hi:[1,0,0]
    v_pk_fma_f32 v[104:105], v[104:105], v[126:127], v[124:125] op_sel_hi:[1,0,0]
    v_pk_fma_f32 v[106:107], v[106:107], v[126:127], v[124:125] op_sel_hi:[1,0,0]
    v_pk_mul_f32 v[100:101], v[100:101], v[176:177]
    v_pk_mul_f32 v[102:103], v[102:103], v[178:179]
    v_pk_mul_f32 v[104:105], v[104:105], v[180:181]
    v_pk_mul_f32 v[106:107], v[106:107], v[182:183]
    v_exp_f32 v100, v100
    v_exp_f32 v101, v101
    v_exp_f32 v102, v102
    v_exp_f32 v103, v103
    v_exp_f32 v104, v104
    v_exp_f32 v105, v105
    v_exp_f32 v106, v106
    v_exp_f32 v107, v107
    v_pk_mul_f32 v[176:177], v[176:177], v[184:185]
    v_pk_mul_f32 v[178:179], v[178:179], v[186:187]
    v_pk_mul_f32 v[180:181], v[180:181], v[188:189]
    v_pk_mul_f32 v[182:183], v[182:183], v[190:191]
    v_pk_fma_f32 v[100:101], v[100:101], v[122:123], v[122:123] op_sel_hi:[1,0,0]
    v_pk_fma_f32 v[102:103], v[102:103], v[122:123], v[122:123] op_sel_hi:[1,0,0]
    v_pk_fma_f32 v[104:105], v[104:105], v[122:123], v[122:123] op_sel_hi:[1,0,0]
    v_pk_fma_f32 v[106:107], v[106:107], v[122:123], v[122:123] op_sel_hi:[1,0,0]
    v_rcp_f32 v100, v100
    v_rcp_f32 v101, v101
    v_rcp_f32 v102, v102
    v_rcp_f32 v103, v103
    v_rcp_f32 v104, v104
    v_rcp_f32 v105, v105
    v_rcp_f32 v106, v106
    v_rcp_f32 v107, v107
    v_pk_mul_f32 v[176:177], v[176:177], v[100:101]
    v_pk_mul_f32 v[178:179], v[178:179], v[102:103]
    v_pk_mul_f32 v[180:181], v[180:181], v[104:105]
    v_pk_mul_f32 v[182:183], v[182:183], v[106:107]
    v_cvt_pk_bf16_f32 v184, v176, v177
    v_cvt_pk_bf16_f32 v185, v178, v179
    v_cvt_pk_bf16_f32 v186, v180, v181
    v_cvt_pk_bf16_f32 v187, v182, v183
    buffer_store_dwordx4 v[184:187], v19, s[72:75], s56 offen offset:3072 sc1
    v_pk_fma_f32 v[240:241], v[64:65], v[120:121], v[240:241] op_sel:[0,1,0] op_sel_hi:[1,1,1]
    v_pk_fma_f32 v[242:243], v[66:67], v[120:121], v[242:243] op_sel:[0,1,0] op_sel_hi:[1,1,1]
    v_pk_fma_f32 v[244:245], v[68:69], v[120:121], v[244:245] op_sel:[0,1,0] op_sel_hi:[1,1,1]
    v_pk_fma_f32 v[246:247], v[70:71], v[120:121], v[246:247] op_sel:[0,1,0] op_sel_hi:[1,1,1]
    v_pk_fma_f32 v[248:249], v[72:73], v[120:121], v[248:249] op_sel:[0,1,0] op_sel_hi:[1,1,1]
    v_pk_fma_f32 v[250:251], v[74:75], v[120:121], v[250:251] op_sel:[0,1,0] op_sel_hi:[1,1,1]
    v_pk_fma_f32 v[252:253], v[76:77], v[120:121], v[252:253] op_sel:[0,1,0] op_sel_hi:[1,1,1]
    v_pk_fma_f32 v[254:255], v[78:79], v[120:121], v[254:255] op_sel:[0,1,0] op_sel_hi:[1,1,1]
    v_pk_mul_f32 v[100:101], v[240:241], v[240:241]
    v_pk_mul_f32 v[102:103], v[242:243], v[242:243]
    v_pk_mul_f32 v[104:105], v[244:245], v[244:245]
    v_pk_mul_f32 v[106:107], v[246:247], v[246:247]
    v_pk_fma_f32 v[100:101], v[100:101], v[126:127], v[124:125] op_sel:[0,1,1] op_sel_hi:[1,1,1]
    v_pk_fma_f32 v[102:103], v[102:103], v[126:127], v[124:125] op_sel:[0,1,1] op_sel_hi:[1,1,1]
    v_pk_fma_f32 v[104:105], v[104:105], v[126:127], v[124:125] op_sel:[0,1,1] op_sel_hi:[1,1,1]
    v_pk_fma_f32 v[106:107], v[106:107], v[126:127], v[124:125] op_sel:[0,1,1] op_sel_hi:[1,1,1]
    v_pk_mul_f32 v[100:101], v[100:101], v[240:241]
    v_pk_mul_f32 v[102:103], v[102:103], v[242:243]
    v_pk_mul_f32 v[104:105], v[104:105], v[244:245]
    v_pk_mul_f32 v[106:107], v[106:107], v[246:247]
    v_exp_f32 v100, v100
    v_exp_f32 v101, v101
    v_exp_f32 v102, v102
    v_exp_f32 v103, v103
    v_exp_f32 v104, v104
    v_exp_f32 v105, v105
    v_exp_f32 v106, v106
    v_exp_f32 v107, v107
    v_pk_mul_f32 v[240:241], v[240:241], v[248:249]
    v_pk_mul_f32 v[242:243], v[242:243], v[250:251]
    v_pk_mul_f32 v[244:245], v[244:245], v[252:253]
    v_pk_mul_f32 v[246:247], v[246:247], v[254:255]
    v_pk_fma_f32 v[100:101], v[100:101], v[122:123], v[122:123] op_sel:[0,1,1] op_sel_hi:[1,1,1]
    v_pk_fma_f32 v[102:103], v[102:103], v[122:123], v[122:123] op_sel:[0,1,1] op_sel_hi:[1,1,1]
    v_pk_fma_f32 v[104:105], v[104:105], v[122:123], v[122:123] op_sel:[0,1,1] op_sel_hi:[1,1,1]
    v_pk_fma_f32 v[106:107], v[106:107], v[122:123], v[122:123] op_sel:[0,1,1] op_sel_hi:[1,1,1]
    v_rcp_f32 v100, v100
    v_rcp_f32 v101, v101
    v_rcp_f32 v102, v102
    v_rcp_f32 v103, v103
    v_rcp_f32 v104, v104
    v_rcp_f32 v105, v105
    v_rcp_f32 v106, v106
    v_rcp_f32 v107, v107
    v_pk_mul_f32 v[240:241], v[240:241], v[100:101]
    v_pk_mul_f32 v[242:243], v[242:243], v[102:103]
    v_pk_mul_f32 v[244:245], v[244:245], v[104:105]
    v_pk_mul_f32 v[246:247], v[246:247], v[106:107]
    v_cvt_pk_bf16_f32 v248, v240, v241
    v_cvt_pk_bf16_f32 v249, v242, v243
    v_cvt_pk_bf16_f32 v250, v244, v245
    v_cvt_pk_bf16_f32 v251, v246, v247
    buffer_store_dwordx4 v[248:251], v19, s[72:75], s55 offen offset:3072 sc1
    s_and_b32 s39, s58, 3
    s_lshl_b32 s37, s57, 2
    s_add_u32 s37, s37, s39
    s_lshr_b32 s38, s58, 2
    s_lshl_b32 s42, s38, 7
    s_and_b32 s44, s36, 1
    s_lshr_b32 s45, s36, 1
    s_lshl_b32 s46, s37, 6
    s_lshl_b32 s47, s36, 4
    s_add_u32 s46, s46, s47
    v_lshrrev_b32 v6, 3, v1
    v_and_b32 v7, 7, v1
    v_add_u32 v8, s46, v6
    v_mul_u32_u24 v14, 896, v8
    v_lshl_add_u32 v14, v7, 4, v14
    v_add_u32 v14, s42, v14
    v_add_u32 v15, 7168, v14
    v_add_u32 v8, s47, v6
    v_mul_u32_u24 v11, 272, v8
    v_lshl_add_u32 v11, v7, 5, v11
    v_and_b32 v3, 31, v1
    v_lshrrev_b32 v4, 5, v1
    v_mul_u32_u24 v10, 272, v3
    v_lshl_add_u32 v10, v4, 4, v10
    s_lshl_b32 s47, s45, 7
    s_mul_i32 s51, s44, 17408
    s_add_u32 s47, s47, s51
    s_mul_i32 s51, s44, 8704
    s_add_u32 s52, s47, s51
    v_add_u32 v90, s52, v10
    s_sub_u32 s52, s47, s51
    s_add_u32 s52, s52, 8704
    v_add_u32 v91, s52, v10
    v_lshlrev_b32 v13, 4, v1
    s_mul_i32 s47, s44, 6144
    s_add_u32 s47, s47, 73728
    v_add_u32 v84, s47, v13
    v_xor_b32 v85, 4096, v84
    v_add_u32 v86, 0x10000, v84
    v_add_u32 v87, 0x10000, v85
    v_lshrrev_b32 v4, 5, v1
    v_bfe_u32 v3, v1, 2, 2
    v_lshl_add_u32 v5, v4, 2, v3
    v_lshlrev_b32 v5, 7, v5
    v_bfe_u32 v6, v1, 4, 1
    v_lshlrev_b32 v6, 1, v6
    v_bfe_u32 v7, v1, 1, 1
    v_add_u32 v6, v6, v7
    s_lshl_b32 s47, s45, 2
    v_add_u32 v6, s47, v6
    v_lshrrev_b32 v7, 1, v3
    v_lshlrev_b32 v7, 2, v7
    v_xor_b32 v6, v6, v7
    v_lshl_add_u32 v5, v6, 4, v5
    v_and_b32 v7, 1, v1
    v_lshl_add_u32 v88, v7, 3, v5
    s_lshl_b32 s47, s44, 12
    v_add_u32 v88, s47, v88
    v_add_u32 v89, 0x10000, v88
    v_add_u32 v92, 0x10000, v89
    s_mov_b32 s50, 0xffff0000
    s_mov_b32 s16, s66
    s_mov_b32 s17, s67
    s_mov_b32 s18, 1835008
    s_mov_b32 s19, 0x20000
    v_lshlrev_b32 v16, 16, v108
    v_and_b32 v17, s50, v108
    v_lshlrev_b32 v18, 16, v109
    v_and_b32 v19, s50, v109
    v_lshlrev_b32 v20, 16, v110
    v_and_b32 v21, s50, v110
    v_lshlrev_b32 v22, 16, v111
    v_and_b32 v23, s50, v111
    v_lshlrev_b32 v24, 16, v112
    v_and_b32 v25, s50, v112
    v_lshlrev_b32 v26, 16, v113
    v_and_b32 v27, s50, v113
    v_lshlrev_b32 v28, 16, v114
    v_and_b32 v29, s50, v114
    v_lshlrev_b32 v30, 16, v115
    v_and_b32 v31, s50, v115
    v_mov_b32 v44, 163836
    v_mov_b32 v45, 1
    s_mov_b64 exec, 1
    s_waitcnt vmcnt(0)
    ds_add_rtn_u32 v45, v44, v45
    s_waitcnt lgkmcnt(0)
    v_readfirstlane_b32 s62, v45
    s_nop 0
    s_and_b32 s62, s62, 3
    s_cmp_lg_u32 s62, 3
    s_cbranch_scc1 mk_12
    v_mov_b32 v44, 0
    v_mov_b32 v45, s63
    buffer_store_dword v45, v44, s[72:75], s61 offen sc1
mk_12:
    s_mov_b64 exec, -1
    s_barrier
    ds_read_b64_tr_b16 v[144:145], v89 offset:8192
    ds_read_b64_tr_b16 v[146:147], v89 offset:9216
    ds_read_b64_tr_b16 v[148:149], v89 offset:10240
    ds_read_b64_tr_b16 v[150:151], v89 offset:11264
    ds_read_b64_tr_b16 v[152:153], v89 offset:16384
    ds_read_b64_tr_b16 v[154:155], v89 offset:17408
    ds_read_b64_tr_b16 v[156:157], v89 offset:18432
    ds_read_b64_tr_b16 v[158:159], v89 offset:19456
    ds_read_b64_tr_b16 v[160:161], v89 offset:24576
    ds_read_b64_tr_b16 v[162:163], v89 offset:25600
    ds_read_b64_tr_b16 v[164:165], v89 offset:26624
    ds_read_b64_tr_b16 v[166:167], v89 offset:27648
    ds_read_b64_tr_b16 v[168:169], v89 offset:32768
    ds_read_b64_tr_b16 v[170:171], v89 offset:33792
    ds_read_b64_tr_b16 v[172:173], v89 offset:34816
    ds_read_b64_tr_b16 v[174:175], v89 offset:35840
    ds_read_b64_tr_b16 v[176:177], v89 offset:40960
    ds_read_b64_tr_b16 v[178:179], v89 offset:41984
    ds_read_b64_tr_b16 v[180:181], v89 offset:43008
    ds_read_b64_tr_b16 v[182:183], v89 offset:44032
    ds_read_b64_tr_b16 v[184:185], v89 offset:49152
    ds_read_b64_tr_b16 v[186:187], v89 offset:50176
    ds_read_b64_tr_b16 v[188:189], v89 offset:51200
    ds_read_b64_tr_b16 v[190:191], v89 offset:52224
    ds_read_b64_tr_b16 v[192:193], v89 offset:57344
    ds_read_b64_tr_b16 v[194:195], v89 offset:58368
    ds_read_b64_tr_b16 v[196:197], v89 offset:59392
    ds_read_b64_tr_b16 v[198:199], v89 offset:60416
    ds_read_b64_tr_b16 v[200:201], v92 offset:0
    ds_read_b64_tr_b16 v[202:203], v92 offset:1024
    ds_read_b64_tr_b16 v[204:205], v92 offset:2048
    ds_read_b64_tr_b16 v[206:207], v92 offset:3072
    ds_read_b64_tr_b16 v[208:209], v92 offset:8192
    ds_read_b64_tr_b16 v[210:211], v92 offset:9216
    ds_read_b64_tr_b16 v[212:213], v92 offset:10240
    ds_read_b64_tr_b16 v[214:215], v92 offset:11264
    ds_read_b64_tr_b16 v[216:217], v92 offset:16384
    ds_read_b64_tr_b16 v[218:219], v92 offset:17408
    ds_read_b64_tr_b16 v[220:221], v92 offset:18432
    ds_read_b64_tr_b16 v[222:223], v92 offset:19456
    ds_read_b64_tr_b16 v[224:225], v88 offset:40960
    ds_read_b64_tr_b16 v[226:227], v88 offset:41984
    ds_read_b64_tr_b16 v[228:229], v88 offset:43008
    ds_read_b64_tr_b16 v[230:231], v88 offset:44032
    ds_read_b64_tr_b16 v[232:233], v88 offset:49152
    ds_read_b64_tr_b16 v[234:235], v88 offset:50176
    ds_read_b64_tr_b16 v[236:237], v88 offset:51200
    ds_read_b64_tr_b16 v[238:239], v88 offset:52224
    ds_read_b64_tr_b16 v[240:241], v88 offset:57344
    ds_read_b64_tr_b16 v[242:243], v88 offset:58368
    ds_read_b64_tr_b16 v[244:245], v88 offset:59392
    ds_read_b64_tr_b16 v[246:247], v88 offset:60416
    ds_read_b64_tr_b16 v[248:249], v89 offset:0
    ds_read_b64_tr_b16 v[250:251], v89 offset:1024
    ds_read_b64_tr_b16 v[252:253], v89 offset:2048
    ds_read_b64_tr_b16 v[254:255], v89 offset:3072
    s_waitcnt lgkmcnt(0)
    s_barrier
    s_barrier
    s_barrier
    ds_read_b128 v[32:35], v84 offset:0
    ds_read_b64_tr_b16 v[40:41], v88 offset:0
    ds_read_b64_tr_b16 v[42:43], v88 offset:1024
    ds_read_b128 v[36:39], v85 offset:0
    ds_read_b128 v[44:47], v84 offset:1024
    ds_read_b64_tr_b16 v[52:53], v88 offset:2048
    ds_read_b64_tr_b16 v[54:55], v88 offset:3072
    ds_read_b128 v[48:51], v85 offset:1024
    s_waitcnt lgkmcnt(4)
    v_mfma_f32_32x32x16_bf16 v[16:31], v[40:43], v[32:35], v[16:31]
    ds_read_b128 v[56:59], v84 offset:8192
    ds_read_b64_tr_b16 v[64:65], v88 offset:8192
    v_mfma_f32_32x32x16_bf16 v[128:143], v[40:43], v[36:39], 0
    ds_read_b64_tr_b16 v[66:67], v88 offset:9216
    ds_read_b128 v[60:63], v85 offset:8192
    s_waitcnt lgkmcnt(4)
    v_mfma_f32_32x32x16_bf16 v[16:31], v[52:55], v[44:47], v[16:31]
    ds_read_b128 v[68:71], v84 offset:9216
    ds_read_b64_tr_b16 v[76:77], v88 offset:10240
    v_mfma_f32_32x32x16_bf16 v[128:143], v[52:55], v[48:51], v[128:143]
    ds_read_b64_tr_b16 v[78:79], v88 offset:11264
    ds_read_b128 v[72:75], v85 offset:9216
    s_barrier
    s_waitcnt lgkmcnt(4)
    v_mfma_f32_32x32x16_bf16 v[16:31], v[64:67], v[56:59], v[16:31]
    ds_read_b128 v[32:35], v84 offset:16384
    ds_read_b64_tr_b16 v[40:41], v88 offset:16384
    v_mfma_f32_32x32x16_bf16 v[128:143], v[64:67], v[60:63], v[128:143]
    ds_read_b64_tr_b16 v[42:43], v88 offset:17408
    ds_read_b128 v[36:39], v85 offset:16384
    s_waitcnt lgkmcnt(4)
    v_mfma_f32_32x32x16_bf16 v[16:31], v[76:79], v[68:71], v[16:31]
    ds_read_b128 v[44:47], v84 offset:17408
    ds_read_b64_tr_b16 v[52:53], v88 offset:18432
    v_mfma_f32_32x32x16_bf16 v[128:143], v[76:79], v[72:75], v[128:143]
    ds_read_b64_tr_b16 v[54:55], v88 offset:19456
    ds_read_b128 v[48:51], v85 offset:17408
    s_waitcnt lgkmcnt(4)
    v_mfma_f32_32x32x16_bf16 v[16:31], v[40:43], v[32:35], v[16:31]
    ds_read_b128 v[56:59], v84 offset:24576
    ds_read_b64_tr_b16 v[64:65], v88 offset:24576
    v_mfma_f32_32x32x16_bf16 v[128:143], v[40:43], v[36:39], v[128:143]
    ds_read_b64_tr_b16 v[66:67], v88 offset:25600
    ds_read_b128 v[60:63], v85 offset:24576
    s_waitcnt lgkmcnt(4)
    v_mfma_f32_32x32x16_bf16 v[16:31], v[52:55], v[44:47], v[16:31]
    ds_read_b128 v[68:71], v84 offset:25600
    ds_read_b64_tr_b16 v[76:77], v88 offset:26624
    v_mfma_f32_32x32x16_bf16 v[128:143], v[52:55], v[48:51], v[128:143]
    ds_read_b64_tr_b16 v[78:79], v88 offset:27648
    ds_read_b128 v[72:75], v85 offset:25600
    s_barrier
    s_waitcnt lgkmcnt(4)
    v_mfma_f32_32x32x16_bf16 v[16:31], v[64:67], v[56:59], v[16:31]
    ds_read_b128 v[32:35], v84 offset:32768
    ds_read_b64_tr_b16 v[40:41], v88 offset:32768
    v_mfma_f32_32x32x16_bf16 v[128:143], v[64:67], v[60:63], v[128:143]
    ds_read_b64_tr_b16 v[42:43], v88 offset:33792
    ds_read_b128 v[36:39], v85 offset:32768
    s_waitcnt lgkmcnt(4)
    v_mfma_f32_32x32x16_bf16 v[16:31], v[76:79], v[68:71], v[16:31]
    ds_read_b128 v[44:47], v84 offset:33792
    ds_read_b64_tr_b16 v[52:53], v88 offset:34816
    v_mfma_f32_32x32x16_bf16 v[128:143], v[76:79], v[72:75], v[128:143]
    ds_read_b64_tr_b16 v[54:55], v88 offset:35840
    ds_read_b128 v[48:51], v85 offset:33792
    s_waitcnt lgkmcnt(4)
    v_mfma_f32_32x32x16_bf16 v[16:31], v[40:43], v[32:35], v[16:31]
    ds_read_b128 v[56:59], v84 offset:40960
    ds_read_b64_tr_b16 v[64:65], v88 offset:40960
    v_mfma_f32_32x32x16_bf16 v[128:143], v[40:43], v[36:39], v[128:143]
    ds_read_b64_tr_b16 v[66:67], v88 offset:41984
    ds_read_b128 v[60:63], v85 offset:40960
    s_waitcnt lgkmcnt(4)
    v_mfma_f32_32x32x16_bf16 v[16:31], v[52:55], v[44:47], v[16:31]
    ds_read_b128 v[68:71], v84 offset:41984
    ds_read_b64_tr_b16 v[76:77], v88 offset:43008
    v_mfma_f32_32x32x16_bf16 v[128:143], v[52:55], v[48:51], v[128:143]
    ds_read_b64_tr_b16 v[78:79], v88 offset:44032
    ds_read_b128 v[72:75], v85 offset:41984
    s_barrier
    s_waitcnt lgkmcnt(4)
    v_mfma_f32_32x32x16_bf16 v[16:31], v[64:67], v[56:59], v[16:31]
    ds_read_b128 v[32:35], v84 offset:49152
    ds_read_b64_tr_b16 v[40:41], v88 offset:49152
    v_mfma_f32_32x32x16_bf16 v[128:143], v[64:67], v[60:63], v[128:143]
    ds_read_b64_tr_b16 v[42:43], v88 offset:50176
    ds_read_b128 v[36:39], v85 offset:49152
    s_waitcnt lgkmcnt(4)
    v_mfma_f32_32x32x16_bf16 v[16:31], v[76:79], v[68:71], v[16:31]
    ds_read_b128 v[44:47], v84 offset:50176
    ds_read_b64_tr_b16 v[52:53], v88 offset:51200
    v_mfma_f32_32x32x16_bf16 v[128:143], v[76:79], v[72:75], v[128:143]
    ds_read_b64_tr_b16 v[54:55], v88 offset:52224
    ds_read_b128 v[48:51], v85 offset:50176
    s_waitcnt lgkmcnt(4)
    v_mfma_f32_32x32x16_bf16 v[16:31], v[40:43], v[32:35], v[16:31]
    ds_read_b128 v[56:59], v84 offset:57344
    ds_read_b64_tr_b16 v[64:65], v88 offset:57344
    v_mfma_f32_32x32x16_bf16 v[128:143], v[40:43], v[36:39], v[128:143]
    ds_read_b64_tr_b16 v[66:67], v88 offset:58368
    ds_read_b128 v[60:63], v85 offset:57344
    s_waitcnt lgkmcnt(4)
    v_mfma_f32_32x32x16_bf16 v[16:31], v[52:55], v[44:47], v[16:31]
    ds_read_b128 v[68:71], v84 offset:58368
    ds_read_b64_tr_b16 v[76:77], v88 offset:59392
    v_mfma_f32_32x32x16_bf16 v[128:143], v[52:55], v[48:51], v[128:143]
    ds_read_b64_tr_b16 v[78:79], v88 offset:60416
    ds_read_b128 v[72:75], v85 offset:58368
    s_barrier
    s_waitcnt lgkmcnt(4)
    v_mfma_f32_32x32x16_bf16 v[16:31], v[64:67], v[56:59], v[16:31]
    ds_read_b128 v[32:35], v86 offset:0
    ds_read_b64_tr_b16 v[40:41], v89 offset:0
    v_mfma_f32_32x32x16_bf16 v[128:143], v[64:67], v[60:63], v[128:143]
    ds_read_b64_tr_b16 v[42:43], v89 offset:1024
    ds_read_b128 v[36:39], v87 offset:0
    s_waitcnt lgkmcnt(4)
    v_mfma_f32_32x32x16_bf16 v[16:31], v[76:79], v[68:71], v[16:31]
    ds_read_b128 v[44:47], v86 offset:1024
    ds_read_b64_tr_b16 v[52:53], v89 offset:2048
    v_mfma_f32_32x32x16_bf16 v[128:143], v[76:79], v[72:75], v[128:143]
    ds_read_b64_tr_b16 v[54:55], v89 offset:3072
    ds_read_b128 v[48:51], v87 offset:1024
    s_waitcnt lgkmcnt(4)
    v_mfma_f32_32x32x16_bf16 v[16:31], v[40:43], v[32:35], v[16:31]
    ds_read_b128 v[56:59], v86 offset:8192
    ds_read_b64_tr_b16 v[64:65], v88 offset:0
    v_mfma_f32_32x32x16_bf16 v[128:143], v[40:43], v[36:39], v[128:143]
    ds_read_b64_tr_b16 v[66:67], v88 offset:1024
    ds_read_b128 v[60:63], v87 offset:8192
    s_waitcnt lgkmcnt(4)
    v_mfma_f32_32x32x16_bf16 v[16:31], v[52:55], v[44:47], v[16:31]
    ds_read_b128 v[68:71], v86 offset:9216
    ds_read_b64_tr_b16 v[76:77], v88 offset:2048
    v_mfma_f32_32x32x16_bf16 v[128:143], v[52:55], v[48:51], v[128:143]
    ds_read_b64_tr_b16 v[78:79], v88 offset:3072
    ds_read_b128 v[72:75], v87 offset:9216
    s_barrier
    s_waitcnt lgkmcnt(4)
    v_mfma_f32_32x32x16_bf16 v[16:31], v[64:67], v[56:59], v[16:31]
    ds_read_b128 v[32:35], v84 offset:0
    ds_read_b64_tr_b16 v[40:41], v88 offset:8192
    v_mfma_f32_32x32x16_bf16 v[128:143], v[64:67], v[60:63], v[128:143]
    ds_read_b64_tr_b16 v[42:43], v88 offset:9216
    ds_read_b128 v[36:39], v85 offset:0
    s_waitcnt lgkmcnt(4)
    v_mfma_f32_32x32x16_bf16 v[16:31], v[76:79], v[68:71], v[16:31]
    ds_read_b128 v[44:47], v84 offset:1024
    ds_read_b64_tr_b16 v[52:53], v88 offset:10240
    v_mfma_f32_32x32x16_bf16 v[128:143], v[76:79], v[72:75], v[128:143]
    ds_read_b64_tr_b16 v[54:55], v88 offset:11264
    ds_read_b128 v[48:51], v85 offset:1024
    s_waitcnt lgkmcnt(4)
    v_mfma_f32_32x32x16_bf16 v[16:31], v[40:43], v[32:35], v[16:31]
    ds_read_b128 v[56:59], v84 offset:8192
    ds_read_b64_tr_b16 v[64:65], v88 offset:16384
    v_mfma_f32_32x32x16_bf16 v[128:143], v[40:43], v[36:39], v[128:143]
    ds_read_b64_tr_b16 v[66:67], v88 offset:17408
    ds_read_b128 v[60:63], v85 offset:8192
    s_waitcnt lgkmcnt(4)
    v_mfma_f32_32x32x16_bf16 v[16:31], v[52:55], v[44:47], v[16:31]
    ds_read_b128 v[68:71], v84 offset:9216
    ds_read_b64_tr_b16 v[76:77], v88 offset:18432
    v_mfma_f32_32x32x16_bf16 v[128:143], v[52:55], v[48:51], v[128:143]
    ds_read_b64_tr_b16 v[78:79], v88 offset:19456
    ds_read_b128 v[72:75], v85 offset:9216
    s_barrier
    s_waitcnt lgkmcnt(4)
    v_mfma_f32_32x32x16_bf16 v[16:31], v[64:67], v[56:59], v[16:31]
    ds_read_b128 v[32:35], v84 offset:16384
    ds_read_b64_tr_b16 v[40:41], v88 offset:24576
    v_mfma_f32_32x32x16_bf16 v[128:143], v[64:67], v[60:63], v[128:143]
    ds_read_b64_tr_b16 v[42:43], v88 offset:25600
    ds_read_b128 v[36:39], v85 offset:16384
    s_waitcnt lgkmcnt(4)
    v_mfma_f32_32x32x16_bf16 v[16:31], v[76:79], v[68:71], v[16:31]
    ds_read_b128 v[44:47], v84 offset:17408
    ds_read_b64_tr_b16 v[52:53], v88 offset:26624
    v_mfma_f32_32x32x16_bf16 v[128:143], v[76:79], v[72:75], v[128:143]
    ds_read_b64_tr_b16 v[54:55], v88 offset:27648
    ds_read_b128 v[48:51], v85 offset:17408
    s_waitcnt lgkmcnt(4)
    v_mfma_f32_32x32x16_bf16 v[16:31], v[40:43], v[32:35], v[16:31]
    ds_read_b128 v[56:59], v84 offset:24576
    ds_read_b64_tr_b16 v[64:65], v88 offset:32768
    v_mfma_f32_32x32x16_bf16 v[128:143], v[40:43], v[36:39], v[128:143]
    ds_read_b64_tr_b16 v[66:67], v88 offset:33792
    ds_read_b128 v[60:63], v85 offset:24576
    s_waitcnt lgkmcnt(4)
    v_mfma_f32_32x32x16_bf16 v[16:31], v[52:55], v[44:47], v[16:31]
    ds_read_b128 v[68:71], v84 offset:25600
    ds_read_b64_tr_b16 v[76:77], v88 offset:34816
    v_mfma_f32_32x32x16_bf16 v[128:143], v[52:55], v[48:51], v[128:143]
    ds_read_b64_tr_b16 v[78:79], v88 offset:35840
    ds_read_b128 v[72:75], v85 offset:25600
    s_barrier
    s_waitcnt lgkmcnt(4)
    v_mfma_f32_32x32x16_bf16 v[16:31], v[64:67], v[56:59], v[16:31]
    ds_read_b128 v[32:35], v84 offset:32768
    v_mfma_f32_32x32x16_bf16 v[128:143], v[64:67], v[60:63], v[128:143]
    ds_read_b128 v[36:39], v85 offset:32768
    s_waitcnt lgkmcnt(2)
    v_mfma_f32_32x32x16_bf16 v[16:31], v[76:79], v[68:71], v[16:31]
    ds_read_b128 v[44:47], v84 offset:33792
    v_mfma_f32_32x32x16_bf16 v[128:143], v[76:79], v[72:75], v[128:143]
    ds_read_b128 v[48:51], v85 offset:33792
    s_waitcnt lgkmcnt(2)
    v_mfma_f32_32x32x16_bf16 v[16:31], v[144:147], v[32:35], v[16:31]
    ds_read_b128 v[56:59], v84 offset:40960
    v_mfma_f32_32x32x16_bf16 v[128:143], v[144:147], v[36:39], v[128:143]
    ds_read_b128 v[60:63], v85 offset:40960
    s_waitcnt lgkmcnt(2)
    v_mfma_f32_32x32x16_bf16 v[16:31], v[148:151], v[44:47], v[16:31]
    ds_read_b128 v[68:71], v84 offset:41984
    v_mfma_f32_32x32x16_bf16 v[128:143], v[148:151], v[48:51], v[128:143]
    ds_read_b128 v[72:75], v85 offset:41984
    s_barrier
    s_waitcnt lgkmcnt(2)
    v_mfma_f32_32x32x16_bf16 v[16:31], v[152:155], v[56:59], v[16:31]
    ds_read_b128 v[32:35], v84 offset:49152
    v_mfma_f32_32x32x16_bf16 v[128:143], v[152:155], v[60:63], v[128:143]
    ds_read_b128 v[36:39], v85 offset:49152
    s_waitcnt lgkmcnt(2)
    v_mfma_f32_32x32x16_bf16 v[16:31], v[156:159], v[68:71], v[16:31]
    ds_read_b128 v[44:47], v84 offset:50176
    v_mfma_f32_32x32x16_bf16 v[128:143], v[156:159], v[72:75], v[128:143]
    ds_read_b128 v[48:51], v85 offset:50176
    s_waitcnt lgkmcnt(2)
    v_mfma_f32_32x32x16_bf16 v[16:31], v[160:163], v[32:35], v[16:31]
    ds_read_b128 v[56:59], v84 offset:57344
    v_mfma_f32_32x32x16_bf16 v[128:143], v[160:163], v[36:39], v[128:143]
    ds_read_b128 v[60:63], v85 offset:57344
    s_waitcnt lgkmcnt(2)
    v_mfma_f32_32x32x16_bf16 v[16:31], v[164:167], v[44:47], v[16:31]
    ds_read_b128 v[68:71], v84 offset:58368
    v_mfma_f32_32x32x16_bf16 v[128:143], v[164:167], v[48:51], v[128:143]
    ds_read_b128 v[72:75], v85 offset:58368
    s_barrier
    s_waitcnt lgkmcnt(2)
    v_mfma_f32_32x32x16_bf16 v[16:31], v[168:171], v[56:59], v[16:31]
    ds_read_b128 v[32:35], v86 offset:0
    v_mfma_f32_32x32x16_bf16 v[128:143], v[168:171], v[60:63], v[128:143]
    ds_read_b128 v[36:39], v87 offset:0
    s_waitcnt lgkmcnt(2)
    v_mfma_f32_32x32x16_bf16 v[16:31], v[172:175], v[68:71], v[16:31]
    ds_read_b128 v[44:47], v86 offset:1024
    v_mfma_f32_32x32x16_bf16 v[128:143], v[172:175], v[72:75], v[128:143]
    ds_read_b128 v[48:51], v87 offset:1024
    s_waitcnt lgkmcnt(2)
    v_mfma_f32_32x32x16_bf16 v[16:31], v[176:179], v[32:35], v[16:31]
    ds_read_b128 v[56:59], v86 offset:8192
    v_mfma_f32_32x32x16_bf16 v[128:143], v[176:179], v[36:39], v[128:143]
    ds_read_b128 v[60:63], v87 offset:8192
    s_waitcnt lgkmcnt(2)
    v_mfma_f32_32x32x16_bf16 v[16:31], v[180:183], v[44:47], v[16:31]
    ds_read_b128 v[68:71], v86 offset:9216
    v_mfma_f32_32x32x16_bf16 v[128:143], v[180:183], v[48:51], v[128:143]
    ds_read_b128 v[72:75], v87 offset:9216
    s_barrier
    s_waitcnt lgkmcnt(2)
    v_mfma_f32_32x32x16_bf16 v[16:31], v[184:187], v[56:59], v[16:31]
    ds_read_b128 v[32:35], v84 offset:0
    v_mfma_f32_32x32x16_bf16 v[128:143], v[184:187], v[60:63], v[128:143]
    ds_read_b128 v[36:39], v85 offset:0
    s_waitcnt lgkmcnt(2)
    v_mfma_f32_32x32x16_bf16 v[16:31], v[188:191], v[68:71], v[16:31]
    ds_read_b128 v[44:47], v84 offset:1024
    v_mfma_f32_32x32x16_bf16 v[128:143], v[188:191], v[72:75], v[128:143]
    ds_read_b128 v[48:51], v85 offset:1024
    s_waitcnt lgkmcnt(2)
    v_mfma_f32_32x32x16_bf16 v[16:31], v[192:195], v[32:35], v[16:31]
    ds_read_b128 v[56:59], v84 offset:8192
    v_mfma_f32_32x32x16_bf16 v[128:143], v[192:195], v[36:39], v[128:143]
    ds_read_b128 v[60:63], v85 offset:8192
    s_waitcnt lgkmcnt(2)
    v_mfma_f32_32x32x16_bf16 v[16:31], v[196:199], v[44:47], v[16:31]
    ds_read_b128 v[68:71], v84 offset:9216
    v_mfma_f32_32x32x16_bf16 v[128:143], v[196:199], v[48:51], v[128:143]
    ds_read_b128 v[72:75], v85 offset:9216
    s_barrier
    s_waitcnt lgkmcnt(2)
    v_mfma_f32_32x32x16_bf16 v[16:31], v[200:203], v[56:59], v[16:31]
    ds_read_b128 v[32:35], v84 offset:16384
    v_mfma_f32_32x32x16_bf16 v[128:143], v[200:203], v[60:63], v[128:143]
    ds_read_b128 v[36:39], v85 offset:16384
    s_waitcnt lgkmcnt(2)
    v_mfma_f32_32x32x16_bf16 v[16:31], v[204:207], v[68:71], v[16:31]
    ds_read_b128 v[44:47], v84 offset:17408
    v_mfma_f32_32x32x16_bf16 v[128:143], v[204:207], v[72:75], v[128:143]
    ds_read_b128 v[48:51], v85 offset:17408
    s_waitcnt lgkmcnt(2)
    v_mfma_f32_32x32x16_bf16 v[16:31], v[208:211], v[32:35], v[16:31]
    ds_read_b128 v[56:59], v84 offset:24576
    v_mfma_f32_32x32x16_bf16 v[128:143], v[208:211], v[36:39], v[128:143]
    ds_read_b128 v[60:63], v85 offset:24576
    s_waitcnt lgkmcnt(2)
    v_mfma_f32_32x32x16_bf16 v[16:31], v[212:215], v[44:47], v[16:31]
    ds_read_b128 v[68:71], v84 offset:25600
    v_mfma_f32_32x32x16_bf16 v[128:143], v[212:215], v[48:51], v[128:143]
    ds_read_b128 v[72:75], v85 offset:25600
    s_barrier
    s_waitcnt lgkmcnt(2)
    v_mfma_f32_32x32x16_bf16 v[16:31], v[216:219], v[56:59], v[16:31]
    ds_read_b128 v[32:35], v84 offset:32768
    v_mfma_f32_32x32x16_bf16 v[128:143], v[216:219], v[60:63], v[128:143]
    ds_read_b128 v[36:39], v85 offset:32768
    s_waitcnt lgkmcnt(2)
    v_mfma_f32_32x32x16_bf16 v[16:31], v[220:223], v[68:71], v[16:31]
    ds_read_b128 v[44:47], v84 offset:33792
    v_mfma_f32_32x32x16_bf16 v[128:143], v[220:223], v[72:75], v[128:143]
    ds_read_b128 v[48:51], v85 offset:33792
    s_waitcnt lgkmcnt(2)
    v_mfma_f32_32x32x16_bf16 v[16:31], v[224:227], v[32:35], v[16:31]
    ds_read_b128 v[56:59], v84 offset:40960
    v_mfma_f32_32x32x16_bf16 v[128:143], v[224:227], v[36:39], v[128:143]
    ds_read_b128 v[60:63], v85 offset:40960
    s_waitcnt lgkmcnt(2)
    v_mfma_f32_32x32x16_bf16 v[16:31], v[228:231], v[44:47], v[16:31]
    ds_read_b128 v[68:71], v84 offset:41984
    v_mfma_f32_32x32x16_bf16 v[128:143], v[228:231], v[48:51], v[128:143]
    ds_read_b128 v[72:75], v85 offset:41984
    s_barrier
    s_waitcnt lgkmcnt(2)
    v_mfma_f32_32x32x16_bf16 v[16:31], v[232:235], v[56:59], v[16:31]
    ds_read_b128 v[32:35], v84 offset:49152
    v_mfma_f32_32x32x16_bf16 v[128:143], v[232:235], v[60:63], v[128:143]
    ds_read_b128 v[36:39], v85 offset:49152
    s_waitcnt lgkmcnt(2)
    v_mfma_f32_32x32x16_bf16 v[16:31], v[236:239], v[68:71], v[16:31]
    ds_read_b128 v[44:47], v84 offset:50176
    v_mfma_f32_32x32x16_bf16 v[128:143], v[236:239], v[72:75], v[128:143]
    ds_read_b128 v[48:51], v85 offset:50176
    s_waitcnt lgkmcnt(2)
    v_mfma_f32_32x32x16_bf16 v[16:31], v[240:243], v[32:35], v[16:31]
    ds_read_b128 v[56:59], v84 offset:57344
    v_mfma_f32_32x32x16_bf16 v[128:143], v[240:243], v[36:39], v[128:143]
    ds_read_b128 v[60:63], v85 offset:57344
    s_waitcnt lgkmcnt(2)
    v_mfma_f32_32x32x16_bf16 v[16:31], v[244:247], v[44:47], v[16:31]
    ds_read_b128 v[68:71], v84 offset:58368
    v_mfma_f32_32x32x16_bf16 v[128:143], v[244:247], v[48:51], v[128:143]
    ds_read_b128 v[72:75], v85 offset:58368
    s_waitcnt lgkmcnt(2)
    v_mfma_f32_32x32x16_bf16 v[16:31], v[248:251], v[56:59], v[16:31]
    v_mfma_f32_32x32x16_bf16 v[128:143], v[248:251], v[60:63], v[128:143]
    s_waitcnt lgkmcnt(0)
    v_mfma_f32_32x32x16_bf16 v[16:31], v[252:255], v[68:71], v[16:31]
    v_mfma_f32_32x32x16_bf16 v[128:143], v[252:255], v[72:75], v[128:143]
    s_nop 10
    ds_write_b128 v90, v[16:19] offset:0
    ds_write_b128 v90, v[20:23] offset:32
    ds_write_b128 v90, v[24:27] offset:64
    ds_write_b128 v90, v[28:31] offset:96
    ds_write_b128 v91, v[128:131] offset:0
    ds_write_b128 v91, v[132:135] offset:32
    ds_write_b128 v91, v[136:139] offset:64
    ds_write_b128 v91, v[140:143] offset:96
    s_waitcnt lgkmcnt(0)
    s_barrier
    ds_read_b128 v[32:35], v11 offset:0
    ds_read_b128 v[36:39], v11 offset:16
    ds_read_b128 v[40:43], v11 offset:17408
    ds_read_b128 v[44:47], v11 offset:17424
    ds_read_b128 v[48:51], v11 offset:2176
    ds_read_b128 v[52:55], v11 offset:2192
    ds_read_b128 v[56:59], v11 offset:19584
    ds_read_b128 v[60:63], v11 offset:19600
    s_waitcnt lgkmcnt(4)
    v_pk_add_f32 v[32:33], v[32:33], v[40:41]
    v_pk_add_f32 v[34:35], v[34:35], v[42:43]
    v_pk_add_f32 v[36:37], v[36:37], v[44:45]
    v_pk_add_f32 v[38:39], v[38:39], v[46:47]
    v_cvt_pk_bf16_f32 v64, v32, v33
    v_cvt_pk_bf16_f32 v65, v34, v35
    v_cvt_pk_bf16_f32 v66, v36, v37
    v_cvt_pk_bf16_f32 v67, v38, v39
    buffer_store_dwordx4 v[64:67], v14, s[16:19], 0 offen
    s_waitcnt lgkmcnt(0)
    v_pk_add_f32 v[48:49], v[48:49], v[56:57]
    v_pk_add_f32 v[50:51], v[50:51], v[58:59]
    v_pk_add_f32 v[52:53], v[52:53], v[60:61]
    v_pk_add_f32 v[54:55], v[54:55], v[62:63]
    v_cvt_pk_bf16_f32 v68, v48, v49
    v_cvt_pk_bf16_f32 v69, v50, v51
    v_cvt_pk_bf16_f32 v70, v52, v53
    v_cvt_pk_bf16_f32 v71, v54, v55
    buffer_store_dwordx4 v[68:71], v15, s[16:19], 0 offen
    s_endpgm
mk_colsum:
    s_cmp_ge_u32 s2, 252
    s_cbranch_scc1 mk_tw
    s_sub_u32 s37, s2, 224
    s_cmp_ge_u32 s37, 14
    s_cselect_b32 s38, 14, 0
    s_cselect_b32 s16, s14, s12
    s_cselect_b32 s17, s15, s13
    s_sub_u32 s38, s37, s38
    s_lshl_b32 s38, s38, 8
    s_mov_b32 s18, 1605632
    s_mov_b32 s19, 0x20000
    v_lshrrev_b32 v3, 4, v1
    s_mul_i32 s39, s36, 56
    v_add_u32 v3, s39, v3
    v_mul_u32_u24 v3, 3584, v3
    v_and_b32 v4, 15, v1
    v_lshl_add_u32 v3, v4, 4, v3
    v_add_u32 v3, s38, v3
    s_mov_b32 s40, 0
    buffer_load_dwordx4 v[32:35], v3, s[16:19], s40 offen
    s_mov_b32 s40, 14336
    buffer_load_dwordx4 v[36:39], v3, s[16:19], s40 offen
    s_mov_b32 s40, 28672
    buffer_load_dwordx4 v[40:43], v3, s[16:19], s40 offen
    s_mov_b32 s40, 43008
    buffer_load_dwordx4 v[44:47], v3, s[16:19], s40 offen
    s_mov_b32 s40, 57344
    buffer_load_dwordx4 v[48:51], v3, s[16:19], s40 offen
    s_mov_b32 s40, 71680
    buffer_load_dwordx4 v[52:55], v3, s[16:19], s40 offen
    s_mov_b32 s40, 86016
    buffer_load_dwordx4 v[56:59], v3, s[16:19], s40 offen
    s_mov_b32 s40, 100352
    buffer_load_dwordx4 v[60:63], v3, s[16:19], s40 offen
    s_mov_b32 s40, 114688
    buffer_load_dwordx4 v[64:67], v3, s[16:19], s40 offen
    s_mov_b32 s40, 129024
    buffer_load_dwordx4 v[68:71], v3, s[16:19], s40 offen
    s_mov_b32 s40, 143360
    buffer_load_dwordx4 v[72:75], v3, s[16:19], s40 offen
    s_mov_b32 s40, 157696
    buffer_load_dwordx4 v[76:79], v3, s[16:19], s40 offen
    s_mov_b32 s40, 172032
    buffer_load_dwordx4 v[80:83], v3, s[16:19], s40 offen
    s_mov_b32 s40, 186368
    buffer_load_dwordx4 v[84:87], v3, s[16:19], s40 offen
    s_mov_b32 s50, 0xffff0000
    s_waitcnt vmcnt(13)
    v_lshlrev_b32 v8, 16, v32
    v_and_b32 v9, s50, v32
    v_lshlrev_b32 v10, 16, v33
    v_and_b32 v11, s50, v33
    v_lshlrev_b32 v12, 16, v34
    v_and_b32 v13, s50, v34
    v_lshlrev_b32 v14, 16, v35
    v_and_b32 v15, s50, v35
    s_waitcnt vmcnt(12)
    v_lshlrev_b32 v16, 16, v36
    v_and_b32 v17, s50, v36
    v_add_f32 v8, v8, v16
    v_add_f32 v9, v9, v17
    v_lshlrev_b32 v16, 16, v37
    v_and_b32 v17, s50, v37
    v_add_f32 v10, v10, v16
    v_add_f32 v11, v11, v17
    v_lshlrev_b32 v16, 16, v38
    v_and_b32 v17, s50, v38
    v_add_f32 v12, v12, v16
    v_add_f32 v13, v13, v17
    v_lshlrev_b32 v16, 16, v39
    v_and_b32 v17, s50, v39
    v_add_f32 v14, v14, v16
    v_add_f32 v15, v15, v17
    s_waitcnt vmcnt(11)
    v_lshlrev_b32 v16, 16, v40
    v_and_b32 v17, s50, v40
    v_add_f32 v8, v8, v16
    v_add_f32 v9, v9, v17
    v_lshlrev_b32 v16, 16, v41
    v_and_b32 v17, s50, v41
    v_add_f32 v10, v10, v16
    v_add_f32 v11, v11, v17
    v_lshlrev_b32 v16, 16, v42
    v_and_b32 v17, s50, v42
    v_add_f32 v12, v12, v16
    v_add_f32 v13, v13, v17
    v_lshlrev_b32 v16, 16, v43
    v_and_b32 v17, s50, v43
    v_add_f32 v14, v14, v16
    v_add_f32 v15, v15, v17
    s_waitcnt vmcnt(10)
    v_lshlrev_b32 v16, 16, v44
    v_and_b32 v17, s50, v44
    v_add_f32 v8, v8, v16
    v_add_f32 v9, v9, v17
    v_lshlrev_b32 v16, 16, v45
    v_and_b32 v17, s50, v45
    v_add_f32 v10, v10, v16
    v_add_f32 v11, v11, v17
    v_lshlrev_b32 v16, 16, v46
    v_and_b32 v17, s50, v46
    v_add_f32 v12, v12, v16
    v_add_f32 v13, v13, v17
    v_lshlrev_b32 v16, 16, v47
    v_and_b32 v17, s50, v47
    v_add_f32 v14, v14, v16
    v_add_f32 v15, v15, v17
    s_waitcnt vmcnt(9)
    v_lshlrev_b32 v16, 16, v48
    v_and_b32 v17, s50, v48
    v_add_f32 v8, v8, v16
    v_add_f32 v9, v9, v17
    v_lshlrev_b32 v16, 16, v49
    v_and_b32 v17, s50, v49
    v_add_f32 v10, v10, v16
    v_add_f32 v11, v11, v17
    v_lshlrev_b32 v16, 16, v50
    v_and_b32 v17, s50, v50
    v_add_f32 v12, v12, v16
    v_add_f32 v13, v13, v17
    v_lshlrev_b32 v16, 16, v51
    v_and_b32 v17, s50, v51
    v_add_f32 v14, v14, v16
    v_add_f32 v15, v15, v17
    s_waitcnt vmcnt(8)
    v_lshlrev_b32 v16, 16, v52
    v_and_b32 v17, s50, v52
    v_add_f32 v8, v8, v16
    v_add_f32 v9, v9, v17
    v_lshlrev_b32 v16, 16, v53
    v_and_b32 v17, s50, v53
    v_add_f32 v10, v10, v16
    v_add_f32 v11, v11, v17
    v_lshlrev_b32 v16, 16, v54
    v_and_b32 v17, s50, v54
    v_add_f32 v12, v12, v16
    v_add_f32 v13, v13, v17
    v_lshlrev_b32 v16, 16, v55
    v_and_b32 v17, s50, v55
    v_add_f32 v14, v14, v16
    v_add_f32 v15, v15, v17
    s_waitcnt vmcnt(7)
    v_lshlrev_b32 v16, 16, v56
    v_and_b32 v17, s50, v56
    v_add_f32 v8, v8, v16
    v_add_f32 v9, v9, v17
    v_lshlrev_b32 v16, 16, v57
    v_and_b32 v17, s50, v57
    v_add_f32 v10, v10, v16
    v_add_f32 v11, v11, v17
    v_lshlrev_b32 v16, 16, v58
    v_and_b32 v17, s50, v58
    v_add_f32 v12, v12, v16
    v_add_f32 v13, v13, v17
    v_lshlrev_b32 v16, 16, v59
    v_and_b32 v17, s50, v59
    v_add_f32 v14, v14, v16
    v_add_f32 v15, v15, v17
    s_waitcnt vmcnt(6)
    v_lshlrev_b32 v16, 16, v60
    v_and_b32 v17, s50, v60
    v_add_f32 v8, v8, v16
    v_add_f32 v9, v9, v17
    v_lshlrev_b32 v16, 16, v61
    v_and_b32 v17, s50, v61
    v_add_f32 v10, v10, v16
    v_add_f32 v11, v11, v17
    v_lshlrev_b32 v16, 16, v62
    v_and_b32 v17, s50, v62
    v_add_f32 v12, v12, v16
    v_add_f32 v13, v13, v17
    v_lshlrev_b32 v16, 16, v63
    v_and_b32 v17, s50, v63
    v_add_f32 v14, v14, v16
    v_add_f32 v15, v15, v17
    s_waitcnt vmcnt(5)
    v_lshlrev_b32 v16, 16, v64
    v_and_b32 v17, s50, v64
    v_add_f32 v8, v8, v16
    v_add_f32 v9, v9, v17
    v_lshlrev_b32 v16, 16, v65
    v_and_b32 v17, s50, v65
    v_add_f32 v10, v10, v16
    v_add_f32 v11, v11, v17
    v_lshlrev_b32 v16, 16, v66
    v_and_b32 v17, s50, v66
    v_add_f32 v12, v12, v16
    v_add_f32 v13, v13, v17
    v_lshlrev_b32 v16, 16, v67
    v_and_b32 v17, s50, v67
    v_add_f32 v14, v14, v16
    v_add_f32 v15, v15, v17
    s_waitcnt vmcnt(4)
    v_lshlrev_b32 v16, 16, v68
    v_and_b32 v17, s50, v68
    v_add_f32 v8, v8, v16
    v_add_f32 v9, v9, v17
    v_lshlrev_b32 v16, 16, v69
    v_and_b32 v17, s50, v69
    v_add_f32 v10, v10, v16
    v_add_f32 v11, v11, v17
    v_lshlrev_b32 v16, 16, v70
    v_and_b32 v17, s50, v70
    v_add_f32 v12, v12, v16
    v_add_f32 v13, v13, v17
    v_lshlrev_b32 v16, 16, v71
    v_and_b32 v17, s50, v71
    v_add_f32 v14, v14, v16
    v_add_f32 v15, v15, v17
    s_waitcnt vmcnt(3)
    v_lshlrev_b32 v16, 16, v72
    v_and_b32 v17, s50, v72
    v_add_f32 v8, v8, v16
    v_add_f32 v9, v9, v17
    v_lshlrev_b32 v16, 16, v73
    v_and_b32 v17, s50, v73
    v_add_f32 v10, v10, v16
    v_add_f32 v11, v11, v17
    v_lshlrev_b32 v16, 16, v74
    v_and_b32 v17, s50, v74
    v_add_f32 v12, v12, v16
    v_add_f32 v13, v13, v17
    v_lshlrev_b32 v16, 16, v75
    v_and_b32 v17, s50, v75
    v_add_f32 v14, v14, v16
    v_add_f32 v15, v15, v17
    s_waitcnt vmcnt(2)
    v_lshlrev_b32 v16, 16, v76
    v_and_b32 v17, s50, v76
    v_add_f32 v8, v8, v16
    v_add_f32 v9, v9, v17
    v_lshlrev_b32 v16, 16, v77
    v_and_b32 v17, s50, v77
    v_add_f32 v10, v10, v16
    v_add_f32 v11, v11, v17
    v_lshlrev_b32 v16, 16, v78
    v_and_b32 v17, s50, v78
    v_add_f32 v12, v12, v16
    v_add_f32 v13, v13, v17
    v_lshlrev_b32 v16, 16, v79
    v_and_b32 v17, s50, v79
    v_add_f32 v14, v14, v16
    v_add_f32 v15, v15, v17
    s_waitcnt vmcnt(1)
    v_lshlrev_b32 v16, 16, v80
    v_and_b32 v17, s50, v80
    v_add_f32 v8, v8, v16
    v_add_f32 v9, v9, v17
    v_lshlrev_b32 v16, 16, v81
    v_and_b32 v17, s50, v81
    v_add_f32 v10, v10, v16
    v_add_f32 v11, v11, v17
    v_lshlrev_b32 v16, 16, v82
    v_and_b32 v17, s50, v82
    v_add_f32 v12, v12, v16
    v_add_f32 v13, v13, v17
    v_lshlrev_b32 v16, 16, v83
    v_and_b32 v17, s50, v83
    v_add_f32 v14, v14, v16
    v_add_f32 v15, v15, v17
    s_waitcnt vmcnt(0)
    v_lshlrev_b32 v16, 16, v84
    v_and_b32 v17, s50, v84
    v_add_f32 v8, v8, v16
    v_add_f32 v9, v9, v17
    v_lshlrev_b32 v16, 16, v85
    v_and_b32 v17, s50, v85
    v_add_f32 v10, v10, v16
    v_add_f32 v11, v11, v17
    v_lshlrev_b32 v16, 16, v86
    v_and_b32 v17, s50, v86
    v_add_f32 v12, v12, v16
    v_add_f32 v13, v13, v17
    v_lshlrev_b32 v16, 16, v87
    v_and_b32 v17, s50, v87
    v_add_f32 v14, v14, v16
    v_add_f32 v15, v15, v17
    v_lshlrev_b32 v5, 5, v0
    ds_write_b128 v5, v[8:11]
    ds_write_b128 v5, v[12:15] offset:16
    s_waitcnt lgkmcnt(0)
    s_barrier
    s_cmp_ge_u32 s36, 2
    s_cbranch_scc1 mk_tws
    v_lshlrev_b32 v5, 2, v0
    ds_read_b32 v32, v5 offset:0
    ds_read_b32 v33, v5 offset:512
    ds_read_b32 v34, v5 offset:1024
    ds_read_b32 v35, v5 offset:1536
    ds_read_b32 v36, v5 offset:2048
    ds_read_b32 v37, v5 offset:2560
    ds_read_b32 v38, v5 offset:3072
    ds_read_b32 v39, v5 offset:3584
    ds_read_b32 v40, v5 offset:4096
    ds_read_b32 v41, v5 offset:4608
    ds_read_b32 v42, v5 offset:5120
    ds_read_b32 v43, v5 offset:5632
    ds_read_b32 v44, v5 offset:6144
    ds_read_b32 v45, v5 offset:6656
    ds_read_b32 v46, v5 offset:7168
    ds_read_b32 v47, v5 offset:7680
    ds_read_b32 v48, v5 offset:8192
    ds_read_b32 v49, v5 offset:8704
    ds_read_b32 v50, v5 offset:9216
    ds_read_b32 v51, v5 offset:9728
    ds_read_b32 v52, v5 offset:10240
    ds_read_b32 v53, v5 offset:10752
    ds_read_b32 v54, v5 offset:11264
    ds_read_b32 v55, v5 offset:11776
    ds_read_b32 v56, v5 offset:12288
    ds_read_b32 v57, v5 offset:12800
    ds_read_b32 v58, v5 offset:13312
    ds_read_b32 v59, v5 offset:13824
    ds_read_b32 v60, v5 offset:14336
    ds_read_b32 v61, v5 offset:14848
    ds_read_b32 v62, v5 offset:15360
    ds_read_b32 v63, v5 offset:15872
    s_waitcnt lgkmcnt(0)
    v_add_f32 v32, v32, v48
    v_add_f32 v33, v33, v49
    v_add_f32 v34, v34, v50
    v_add_f32 v35, v35, v51
    v_add_f32 v36, v36, v52
    v_add_f32 v37, v37, v53
    v_add_f32 v38, v38, v54
    v_add_f32 v39, v39, v55
    v_add_f32 v40, v40, v56
    v_add_f32 v41, v41, v57
    v_add_f32 v42, v42, v58
    v_add_f32 v43, v43, v59
    v_add_f32 v44, v44, v60
    v_add_f32 v45, v45, v61
    v_add_f32 v46, v46, v62
    v_add_f32 v47, v47, v63
    v_add_f32 v32, v32, v40
    v_add_f32 v33, v33, v41
    v_add_f32 v34, v34, v42
    v_add_f32 v35, v35, v43
    v_add_f32 v36, v36, v44
    v_add_f32 v37, v37, v45
    v_add_f32 v38, v38, v46
    v_add_f32 v39, v39, v47
    v_add_f32 v32, v32, v36
    v_add_f32 v33, v33, v37
    v_add_f32 v34, v34, v38
    v_add_f32 v35, v35, v39
    v_add_f32 v32, v32, v34
    v_add_f32 v33, v33, v35
    v_add_f32 v32, v32, v33
    s_lshl_b32 s41, s37, 9
    s_add_u32 s41, s41, 13631488
    buffer_store_dword v32, v5, s[72:75], s41 offen sc1
    s_lshl_b32 s61, s37, 1
    s_add_u32 s61, s61, s36
    s_lshl_b32 s61, s61, 8
    s_add_u32 s61, s61, 38076416
    v_mov_b32 v44, 163836
    v_mov_b32 v45, 1
    s_mov_b64 exec, 1
    s_waitcnt vmcnt(0)
    v_mov_b32 v44, 0
    v_mov_b32 v45, s63
    buffer_store_dword v45, v44, s[72:75], s61 offen sc1
mk_13:
    s_mov_b64 exec, -1
    s_mov_b64 exec, -1
    s_waitcnt vmcnt(0)
mk_tws:
    s_barrier
mk_tw:
    s_mov_b32 s16, s64
    s_mov_b32 s17, s65
    s_mov_b32 s18, 1605632
    s_mov_b32 s19, 0x20000
    s_sub_u32 s40, s2, 224
    s_lshl_b32 s40, s40, 3
    s_add_u32 s40, s40, s36
    s_mul_i32 s40, s40, 6272
    v_min_u32 v3, 16, v1
    v_lshlrev_b32 v3, 7, v3
    buffer_load_dword v4, v3, s[16:19], s40 offen
    s_waitcnt vmcnt(0)
    s_add_u32 s40, s40, 2176
    buffer_load_dword v4, v3, s[16:19], s40 offen
    s_waitcnt vmcnt(0)
    s_add_u32 s40, s40, 2176
    buffer_load_dword v4, v3, s[16:19], s40 offen
    s_waitcnt vmcnt(0)
    s_add_u32 s40, s40, 2176
mk_end:
    s_endpgm
code_end:
    s_endpgm
.section .rodata,"a"
.p2align 6
.amdhsa_kernel sequential_preLN__sliding_block__glu_gated_geglu__prompt_kernel
  .amdhsa_next_free_vgpr 256
  .amdhsa_next_free_sgpr 102
  .amdhsa_accum_offset 256
  .amdhsa_group_segment_fixed_size 0
  .amdhsa_kernarg_size 80
  .amdhsa_user_sgpr_count 2
  .amdhsa_user_sgpr_kernarg_segment_ptr 1
  .amdhsa_system_sgpr_workgroup_id_x 1
  .amdhsa_float_denorm_mode_32 3
  .amdhsa_float_denorm_mode_16_64 3
.end_amdhsa_kernel
```
